```python
import torch

def _softmax(x, axis=-1):
    return torch.softmax(x, dim=axis)

def _gelu(x):
    return torch.nn.functional.gelu(x, approximate='tanh')

def _silu(x):
    return torch.nn.functional.silu(x)

def _sigmoid(x):
    return torch.sigmoid(x)

def _layernorm(x, axis=-1, eps=1e-05):
    m = x.mean(dim=axis, keepdim=True)
    v = x.var(dim=axis, keepdim=True, unbiased=False)
    return (x - m) / torch.sqrt(v + eps)

def _scatter_add(tgt, idx, src, axis=0):
    return tgt.clone().index_add_(axis, idx, src)

def _segment_sum(src, seg, n):
    out = torch.zeros((n,) + src.shape[1:], dtype=src.dtype)
    return out.index_add_(0, seg, src)

def _pad(x, pw):
    flat = tuple((v for pair in reversed(pw) for v in pair))
    return torch.nn.functional.pad(x, flat)
kernel_name = 'gated_mix__softmax_full_mha__mixer_gmlp__prompt'

def setup_inputs():

    _w = lambda a: (lambda t: t.to(torch.bfloat16) if t.is_floating_point() else t)(torch.as_tensor(a))

    def _A_setup():
        B, S, D = (1, 2048, 512)
        return {'x': _w((lambda *s: torch.randn(*s, dtype=torch.bfloat16) * 0.05)(B, S, D)), 'wqkv': _w((lambda *s: torch.randn(*s, dtype=torch.bfloat16) * 1.6)(D, 3 * D)), 'wo': _w((lambda *s: torch.randn(*s, dtype=torch.bfloat16) * 0.1)(D, D))}
    _A_in = _A_setup()

    def _B_setup():
        B, S, D, F = (1, 2048, 512, 1792)
        Fh = F // 2
        return {'x': _w((lambda *s: torch.randn(*s, dtype=torch.bfloat16) * 0.05)(B, S, D)), 'w_in': _w((lambda *s: torch.randn(*s, dtype=torch.bfloat16) * 0.8)(D, 2 * Fh)), 'w_sp': _w(0.01 * (lambda *s: torch.randn(*s, dtype=torch.bfloat16) * 0.8)(S, S)), 'b_sp': _w(1.0 + 0.01 * (lambda *s: torch.randn(*s, dtype=torch.bfloat16) * 0.05)(S)), 'w_out': _w((lambda *s: torch.randn(*s, dtype=torch.bfloat16) * 0.05)(Fh, D))}
    _B_in = _B_setup()
    return {'A_x': _A_in['x'], 'A_wqkv': _A_in['wqkv'], 'A_wo': _A_in['wo'], 'B_x': _B_in['x'], 'B_w_in': _B_in['w_in'], 'B_w_sp': _B_in['w_sp'], 'B_b_sp': _B_in['b_sp'], 'B_w_out': _B_in['w_out'], 'gate_w': _w((lambda *s: torch.randn(*s, dtype=torch.bfloat16) * 0.05)(512) * 16.0)}

def reference(A_x, A_wqkv, A_wo, B_x, B_w_in, B_w_sp, B_b_sp, B_w_out, gate_w):

    def _A_ref(x, wqkv, wo):
        B, S, D = x.shape
        H = 32
        Dh = D // H
        qkv = (lambda x, *d: x.permute(*d))((x @ wqkv).reshape(B, S, 3, H, Dh), 2, 0, 3, 1, 4)
        q, k, v = (qkv[0], qkv[1], qkv[2])
        scale = Dh ** (-0.5)
        scores = torch.einsum('bhqd,bhkd->bhqk', q, k) * scale
        p = _softmax(scores, axis=-1)
        o = torch.einsum('bhqk,bhkd->bhqd', p, v)
        return (lambda x, *d: x.permute(*d))(o, 0, 2, 1, 3).reshape(B, S, D) @ wo

    def _B_ref(x, w_in, w_sp, b_sp, w_out):
        B, S, D = x.shape
        F = w_in.shape[-1]
        Fh = F // 2
        z = _gelu(torch.einsum('bsd,df->bsf', x, w_in))
        z1 = z[..., :Fh].clone()
        z2 = _layernorm(z[..., Fh:], axis=-1)
        g = torch.einsum('ts,bsf->btf', w_sp, z2) + b_sp[None, :, None]
        return torch.einsum('bsf,fd->bsd', z1 * g, w_out)
    x = A_x
    g = _sigmoid((x * gate_w).sum(-1, keepdims=True))
    a = _A_ref(x, A_wqkv, A_wo)
    b = _B_ref(x, B_w_in, B_w_sp, B_b_sp, B_w_out)
    return g * a + (1 - g) * b
```

```asm
; @launch grid=(256,1,1) block=(512,1,1) lds=163840
.amdgcn_target "amdgcn-amd-amdhsa--gfx950"
.text
.globl gated_mix__softmax_full_mha__mixer_gmlp__prompt_kernel
.p2align 8
.type gated_mix__softmax_full_mha__mixer_gmlp__prompt_kernel,@function
gated_mix__softmax_full_mha__mixer_gmlp__prompt_kernel:
    s_cmp_ge_u32 s2, 256
    s_cbranch_scc1 L_END
    s_load_dwordx16 s[36:51], s[0:1], 0
    s_load_dwordx8 s[52:59], s[0:1], 64
    v_lshrrev_b32 v5, 6, v0
    v_and_b32 v1, 63, v0
    v_readfirstlane_b32 s24, v5
    s_cmp_ge_u32 s24, 4
    s_cbranch_scc1 L_GSTART
    s_cmp_lg_u32 s24, 3
    s_cbranch_scc1 L_NOPF
    s_getpc_b64 s[22:23]
L_PC:
    s_and_b32 s32, s2, 0xf8
    v_and_b32 v20, 7, v1
    v_add_u32 v20, s32, v20
    v_lshlrev_b32 v20, 7, v20
    v_min_u32 v20, L_END-L_PC, v20
    global_load_dword v0, v20, s[22:23]
L_NOPF:
    s_and_b32 s3, s2, 7
    s_lshr_b32 s4, s2, 3
    s_lshr_b32 s25, s3, 1
    s_lshl_b32 s25, s25, 3
    s_lshr_b32 s6, s4, 2
    s_add_u32 s25, s25, s6
    s_and_b32 s26, s3, 1
    s_lshl_b32 s26, s26, 2
    s_and_b32 s5, s4, 3
    s_add_u32 s26, s26, s5
    s_lshl_b32 s5, s5, 1
    s_add_u32 s6, s6, s5
    s_and_b32 s6, s6, 7
    s_mov_b32 s4, s26
    v_mov_b32 v2, 0
    v_mov_b32 v3, 1
    v_lshlrev_b32 v4, 4, v1
    s_mov_b32 s27, 0
    v_lshrrev_b32 v20, 3, v1
    v_and_b32 v21, 7, v1
    v_lshrrev_b32 v22, 4, v1
    s_setprio 3
    v_xor_b32 v23, v21, v22
    s_lshl_b32 s28, s25, 6
    s_lshl_b32 s29, s24, 4
    s_add_u32 s28, s28, s29
    v_add_u32 v24, s28, v20
    v_lshlrev_b32 v24, 10, v24
    v_lshl_add_u32 v176, v23, 4, v24
    v_xor_b32 v177, 64, v176
    v_add_u32 v177, 7168, v177
    v_add_u32 v20, s29, v20
    v_and_b32 v22, 1, v22
    v_lshlrev_b32 v22, 1, v22
    v_xor_b32 v21, v21, v22
    v_lshlrev_b32 v21, 4, v21
    v_mul_u32_u24 v24, 3584, v20
    s_lshl_b32 s28, s4, 8
    s_add_u32 s28, s28, 1792
    v_add3_u32 v178, v24, v21, s28
    v_xor_b32 v179, 64, v178
    v_add_u32 v179, 27648, v179
    s_lshl_b32 s22, s24, 11
    s_add_u32 s23, s22, 81920
    s_add_u32 s22, s22, 16384
    s_mov_b32 s20, s6
    s_mov_b32 s21, s6
    s_mov_b32 s18, 0x200000
    s_mov_b32 s19, 0x20000
    s_mov_b32 s11, 0x20000
    s_mov_b32 s14, 0x180000
    s_mov_b32 s15, 0x20000
    s_mov_b32 s7, s6
    v_mul_u32_u24 v24, 3072, v20
    s_lshl_b32 s28, s26, 7
    v_add3_u32 v180, v24, v21, s28
    v_xor_b32 v181, 64, v180
    v_add_u32 v181, 23552, v181
    s_cmp_ge_u32 s4, 7
    s_cselect_b32 s10, 0, 0x1c0000
    s_waitcnt lgkmcnt(0)
    s_mov_b64 s[16:17], s[36:37]
    s_mov_b64 s[8:9], s[44:45]
    s_mov_b64 s[12:13], s[38:39]
    s_lshl_b32 s31, s20, 13
    s_add_u32 m0, s31, s22
    s_lshl_b32 s31, s20, 7
    buffer_load_dwordx4 v176, s[16:19], s31 offen lds
    buffer_load_dwordx4 v177, s[16:19], s31 offen offset:1024 lds
    s_add_u32 s20, s20, 1
    s_and_b32 s20, s20, 7
    s_mul_i32 s31, s21, 229376
    s_add_u32 m0, s23, 40960
    s_add_u32 s21, s21, 1
    buffer_load_dwordx4 v178, s[8:11], s31 offen offset:0 lds
    buffer_load_dwordx4 v179, s[8:11], s31 offen offset:1024 lds
    s_add_u32 m0, s23, 49024
    s_and_b32 s21, s21, 7
    buffer_load_dwordx4 v178, s[8:11], s31 offen offset:128 lds
    buffer_load_dwordx4 v179, s[8:11], s31 offen offset:1152 lds
    s_lshl_b32 s31, s20, 13
    s_add_u32 m0, s31, s22
    s_lshl_b32 s31, s20, 7
    buffer_load_dwordx4 v176, s[16:19], s31 offen lds
    buffer_load_dwordx4 v177, s[16:19], s31 offen offset:1024 lds
    s_add_u32 s20, s20, 1
    s_and_b32 s20, s20, 7
    s_mul_i32 s31, s21, 229376
    s_add_u32 m0, s23, 57344
    s_add_u32 s21, s21, 1
    buffer_load_dwordx4 v178, s[8:11], s31 offen offset:0 lds
    buffer_load_dwordx4 v179, s[8:11], s31 offen offset:1024 lds
    s_add_u32 m0, s23, 65408
    s_and_b32 s21, s21, 7
    buffer_load_dwordx4 v178, s[8:11], s31 offen offset:128 lds
    buffer_load_dwordx4 v179, s[8:11], s31 offen offset:1152 lds
    s_mov_b32 s60, s56
    s_mov_b32 s61, s57
    s_mov_b32 s62, 0x100
    s_mov_b32 s63, 0x20000
    s_waitcnt vmcnt(6)
    s_barrier
    s_lshl_b32 s31, s20, 13
    s_add_u32 m0, s31, s22
    s_lshl_b32 s31, s20, 7
    buffer_load_dwordx4 v176, s[16:19], s31 offen lds
    buffer_load_dwordx4 v177, s[16:19], s31 offen offset:1024 lds
    s_add_u32 s20, s20, 1
    s_and_b32 s20, s20, 7
    s_mul_i32 s31, s21, 229376
    s_add_u32 m0, s23, 24576
    s_add_u32 s21, s21, 1
    buffer_load_dwordx4 v178, s[8:11], s31 offen offset:0 lds
    buffer_load_dwordx4 v179, s[8:11], s31 offen offset:1024 lds
    s_add_u32 m0, s23, 32640
    s_and_b32 s21, s21, 7
    buffer_load_dwordx4 v178, s[8:11], s31 offen offset:128 lds
    buffer_load_dwordx4 v179, s[8:11], s31 offen offset:1152 lds
    s_waitcnt vmcnt(6)
    s_barrier
    s_lshl_b32 s31, s20, 13
    s_add_u32 m0, s31, s22
    s_lshl_b32 s31, s20, 7
    buffer_load_dwordx4 v176, s[16:19], s31 offen lds
    buffer_load_dwordx4 v177, s[16:19], s31 offen offset:1024 lds
    s_add_u32 s20, s20, 1
    s_and_b32 s20, s20, 7
    s_mul_i32 s31, s21, 229376
    s_add_u32 m0, s23, 40960
    s_add_u32 s21, s21, 1
    buffer_load_dwordx4 v178, s[8:11], s31 offen offset:0 lds
    buffer_load_dwordx4 v179, s[8:11], s31 offen offset:1024 lds
    s_add_u32 m0, s23, 49024
    s_and_b32 s21, s21, 7
    buffer_load_dwordx4 v178, s[8:11], s31 offen offset:128 lds
    buffer_load_dwordx4 v179, s[8:11], s31 offen offset:1152 lds
    s_mov_b32 s30, 81920
    v_lshrrev_b32 v16, 4, v1
    v_bfe_u32 v17, v1, 2, 2
    v_lshl_add_u32 v16, v16, 3, v17
    v_lshlrev_b32 v16, 7, v16
    v_bfe_u32 v17, v1, 3, 2
    v_lshl_add_u32 v16, v17, 5, v16
    v_and_b32 v17, 3, v1
    v_lshl_add_u32 v16, v17, 3, v16
    v_add_u32 v9, s30, v16
    v_xor_b32 v10, 32, v9
    v_xor_b32 v11, 64, v9
    v_xor_b32 v12, 96, v9
    v_and_b32 v16, 15, v1
    v_lshrrev_b32 v17, 4, v1
    v_bfe_u32 v18, v1, 1, 3
    v_xor_b32 v17, v17, v18
    v_lshlrev_b32 v17, 4, v17
    v_lshl_add_u32 v15, v16, 7, v17
    s_lshl_b32 s32, s24, 5
    v_xor_b32 v10, s32, v9
    s_waitcnt vmcnt(6)
    s_barrier
    s_lshl_b32 s31, s20, 13
    s_add_u32 m0, s31, s22
    s_lshl_b32 s31, s20, 7
    buffer_load_dwordx4 v176, s[16:19], s31 offen lds
    buffer_load_dwordx4 v177, s[16:19], s31 offen offset:1024 lds
    s_add_u32 s20, s20, 1
    s_and_b32 s20, s20, 7
    s_mul_i32 s31, s21, 229376
    s_add_u32 m0, s23, 57344
    s_add_u32 s21, s21, 1
    buffer_load_dwordx4 v178, s[8:11], s31 offen offset:0 lds
    buffer_load_dwordx4 v179, s[8:11], s31 offen offset:1024 lds
    s_add_u32 m0, s23, 65408
    s_and_b32 s21, s21, 7
    buffer_load_dwordx4 v178, s[8:11], s31 offen offset:128 lds
    buffer_load_dwordx4 v179, s[8:11], s31 offen offset:1152 lds
    v_mov_b64 v[128:129], 0
    v_mov_b64 v[130:131], 0
    v_mov_b64 v[132:133], 0
    v_mov_b64 v[134:135], 0
    v_mov_b64 v[136:137], 0
    v_mov_b64 v[138:139], 0
    v_mov_b64 v[140:141], 0
    v_mov_b64 v[142:143], 0
    v_mov_b64 v[144:145], 0
    v_mov_b64 v[146:147], 0
    v_mov_b64 v[148:149], 0
    v_mov_b64 v[150:151], 0
    v_mov_b64 v[152:153], 0
    v_mov_b64 v[154:155], 0
    v_mov_b64 v[156:157], 0
    v_mov_b64 v[158:159], 0
    v_mov_b64 v[160:161], 0
    v_mov_b64 v[162:163], 0
    v_mov_b64 v[164:165], 0
    v_mov_b64 v[166:167], 0
    v_mov_b64 v[168:169], 0
    v_mov_b64 v[170:171], 0
    v_mov_b64 v[172:173], 0
    v_mov_b64 v[174:175], 0
    s_waitcnt vmcnt(6)
    s_barrier
    s_lshl_b32 s31, s20, 13
    s_add_u32 m0, s31, s22
    s_lshl_b32 s31, s20, 7
    buffer_load_dwordx4 v176, s[16:19], s31 offen lds
    buffer_load_dwordx4 v177, s[16:19], s31 offen offset:1024 lds
    s_add_u32 s20, s20, 1
    s_and_b32 s20, s20, 7
    s_mul_i32 s31, s21, 229376
    s_add_u32 m0, s23, 24576
    s_add_u32 s21, s21, 1
    buffer_load_dwordx4 v178, s[8:11], s31 offen offset:0 lds
    buffer_load_dwordx4 v179, s[8:11], s31 offen offset:1024 lds
    s_add_u32 m0, s23, 32640
    s_and_b32 s21, s21, 7
    buffer_load_dwordx4 v178, s[8:11], s31 offen offset:128 lds
    buffer_load_dwordx4 v179, s[8:11], s31 offen offset:1152 lds
    s_lshl_b32 s32, s24, 21
    s_load_dword s97, s[46:47], s32
    s_load_dword s97, s[58:59], s32
    s_add_u32 s32, s32, 0x800000
    s_load_dword s97, s[58:59], s32
    s_add_u32 s32, s32, 0x800000
    s_load_dword s97, s[58:59], s32
    s_add_u32 s32, s32, 0x800000
    s_load_dword s97, s[54:55], 0
    s_load_dword s97, s[48:49], 0
    s_waitcnt vmcnt(6)
    s_barrier
    s_lshl_b32 s31, s20, 13
    s_add_u32 m0, s31, s22
    s_lshl_b32 s31, s20, 7
    buffer_load_dwordx4 v176, s[16:19], s31 offen lds
    buffer_load_dwordx4 v177, s[16:19], s31 offen offset:1024 lds
    s_add_u32 s20, s20, 1
    s_and_b32 s20, s20, 7
    s_mul_i32 s31, s21, 229376
    s_add_u32 m0, s23, 40960
    s_add_u32 s21, s21, 1
    buffer_load_dwordx4 v178, s[8:11], s31 offen offset:0 lds
    buffer_load_dwordx4 v179, s[8:11], s31 offen offset:1024 lds
    s_add_u32 m0, s23, 49024
    s_and_b32 s21, s21, 7
    buffer_load_dwordx4 v178, s[8:11], s31 offen offset:128 lds
    buffer_load_dwordx4 v179, s[8:11], s31 offen offset:1152 lds
    v_and_b32 v16, 15, v1
    v_lshlrev_b32 v16, 4, v16
    v_bfe_u32 v18, v1, 4, 1
    v_lshl_add_u32 v16, v18, 21, v16
    v_lshrrev_b32 v19, 5, v1
    v_lshl_add_u32 v182, v19, 9, v16
    v_and_b32 v17, 3, v1
    v_bfe_u32 v16, v1, 2, 1
    v_lshl_or_b32 v17, v16, 3, v17
    v_bfe_u32 v16, v1, 3, 1
    v_lshl_or_b32 v17, v16, 2, v17
    v_lshlrev_b32 v17, 4, v17
    v_lshl_add_u32 v17, v18, 9, v17
    v_lshl_add_u32 v183, v19, 8, v17
    s_waitcnt vmcnt(6)
    s_barrier
    s_lshl_b32 s31, s20, 13
    s_add_u32 m0, s31, s22
    s_lshl_b32 s31, s20, 7
    buffer_load_dwordx4 v176, s[16:19], s31 offen lds
    buffer_load_dwordx4 v177, s[16:19], s31 offen offset:1024 lds
    s_add_u32 s20, s20, 1
    s_and_b32 s20, s20, 7
    s_mul_i32 s31, s21, 229376
    s_add_u32 m0, s23, 57344
    s_add_u32 s21, s21, 1
    buffer_load_dwordx4 v178, s[8:11], s31 offen offset:0 lds
    buffer_load_dwordx4 v179, s[8:11], s31 offen offset:1024 lds
    s_add_u32 m0, s23, 65408
    s_and_b32 s21, s21, 7
    buffer_load_dwordx4 v178, s[8:11], s31 offen offset:128 lds
    buffer_load_dwordx4 v179, s[8:11], s31 offen offset:1152 lds
    s_mul_i32 s31, s7, 196608
    s_add_u32 m0, s23, 0
    s_add_u32 s7, s7, 1
    buffer_load_dwordx4 v180, s[12:15], s31 offen offset:0 lds
    buffer_load_dwordx4 v181, s[12:15], s31 offen offset:1024 lds
    s_add_u32 m0, s23, 7168
    s_and_b32 s7, s7, 7
    buffer_load_dwordx4 v180, s[12:15], s31 offen offset:1024 lds
    buffer_load_dwordx4 v181, s[12:15], s31 offen offset:2048 lds
    s_add_u32 m0, s23, 14336
    s_nop 0
    buffer_load_dwordx4 v180, s[12:15], s31 offen offset:2048 lds
    buffer_load_dwordx4 v181, s[12:15], s31 offen offset:3072 lds
    s_waitcnt vmcnt(12)
    s_barrier
    s_mov_b32 s16, s58
    s_mov_b32 s17, s59
    s_mov_b32 s18, 0x1800000
    s_mov_b32 s19, 0x20000
    s_waitcnt vmcnt(6)
    s_barrier
    s_mul_i32 s31, s7, 196608
    s_add_u32 m0, s23, 24576
    s_add_u32 s7, s7, 1
    buffer_load_dwordx4 v180, s[12:15], s31 offen offset:0 lds
    buffer_load_dwordx4 v181, s[12:15], s31 offen offset:1024 lds
    s_add_u32 m0, s23, 31744
    s_and_b32 s7, s7, 7
    buffer_load_dwordx4 v180, s[12:15], s31 offen offset:1024 lds
    buffer_load_dwordx4 v181, s[12:15], s31 offen offset:2048 lds
    s_add_u32 m0, s23, 38912
    s_nop 0
    buffer_load_dwordx4 v180, s[12:15], s31 offen offset:2048 lds
    buffer_load_dwordx4 v181, s[12:15], s31 offen offset:3072 lds
    s_mov_b32 s33, 0
    s_mov_b32 s5, 0
    s_lshl_b32 s32, s6, 13
    s_add_u32 s32, s32, 16384
    v_add_u32 v13, s32, v15
    v_xor_b32 v14, 64, v13
    v_add_u32 v9, s33, v10
    s_add_u32 s6, s6, 1
    s_and_b32 s6, s6, 7
    s_add_u32 s33, s33, 24576
    s_cmp_eq_u32 s33, 73728
    s_cselect_b32 s33, 0, s33
    s_waitcnt vmcnt(6)
    s_barrier
.p2align 3
    ds_read_b64_tr_b16 v[48:49], v9 offset:0
    ds_read_b64_tr_b16 v[50:51], v9 offset:512
    ds_read_b64_tr_b16 v[52:53], v9 offset:4096
    ds_read_b64_tr_b16 v[54:55], v9 offset:4608
    ds_read_b64_tr_b16 v[56:57], v9 offset:8192
    ds_read_b64_tr_b16 v[58:59], v9 offset:8704
    ds_read_b64_tr_b16 v[60:61], v9 offset:12288
    ds_read_b64_tr_b16 v[62:63], v9 offset:12800
    ds_read_b64_tr_b16 v[64:65], v9 offset:16384
    ds_read_b64_tr_b16 v[66:67], v9 offset:16896
    ds_read_b64_tr_b16 v[68:69], v9 offset:20480
    ds_read_b64_tr_b16 v[70:71], v9 offset:20992
    ds_read_b128 v[16:19], v13 offset:0
    ds_read_b128 v[20:23], v14 offset:0
    s_waitcnt lgkmcnt(8)
    s_nop 0
    ds_read_b128 v[24:27], v13 offset:2048
    ds_read_b128 v[28:31], v14 offset:2048
    ds_read_b128 v[32:35], v13 offset:4096
    ds_read_b128 v[36:39], v14 offset:4096
    ds_read_b128 v[40:43], v13 offset:6144
    ds_read_b128 v[44:47], v14 offset:6144
    s_waitcnt vmcnt(0) lgkmcnt(0)
L_QLOOP:
    s_lshl_b32 s32, s6, 13
    s_add_u32 s32, s32, 16384
    v_add_u32 v13, s32, v15
    v_xor_b32 v14, 64, v13
    v_add_u32 v9, s33, v10
    s_add_u32 s6, s6, 1
    s_and_b32 s6, s6, 7
    s_add_u32 s33, s33, 24576
    s_cmp_eq_u32 s33, 73728
    s_cselect_b32 s33, 0, s33
    s_barrier
.p2align 3
    ds_read_b64_tr_b16 v[104:105], v9 offset:0
    v_mfma_f32_16x16x32_bf16 v[128:131], v[48:51], v[16:19], v[128:131]
    ds_read_b64_tr_b16 v[106:107], v9 offset:512
    v_mfma_f32_16x16x32_bf16 v[128:131], v[52:55], v[20:23], v[128:131]
    ds_read_b64_tr_b16 v[108:109], v9 offset:4096
    v_mfma_f32_16x16x32_bf16 v[132:135], v[48:51], v[24:27], v[132:135]
    ds_read_b64_tr_b16 v[110:111], v9 offset:4608
    v_mfma_f32_16x16x32_bf16 v[132:135], v[52:55], v[28:31], v[132:135]
    ds_read_b64_tr_b16 v[112:113], v9 offset:8192
    v_mfma_f32_16x16x32_bf16 v[136:139], v[48:51], v[32:35], v[136:139]
    ds_read_b64_tr_b16 v[114:115], v9 offset:8704
    v_mfma_f32_16x16x32_bf16 v[136:139], v[52:55], v[36:39], v[136:139]
    ds_read_b64_tr_b16 v[116:117], v9 offset:12288
    v_mfma_f32_16x16x32_bf16 v[140:143], v[48:51], v[40:43], v[140:143]
    ds_read_b64_tr_b16 v[118:119], v9 offset:12800
    v_mfma_f32_16x16x32_bf16 v[140:143], v[52:55], v[44:47], v[140:143]
    ds_read_b64_tr_b16 v[120:121], v9 offset:16384
    v_mfma_f32_16x16x32_bf16 v[144:147], v[56:59], v[16:19], v[144:147]
    ds_read_b64_tr_b16 v[122:123], v9 offset:16896
    v_mfma_f32_16x16x32_bf16 v[144:147], v[60:63], v[20:23], v[144:147]
    ds_read_b64_tr_b16 v[124:125], v9 offset:20480
    v_mfma_f32_16x16x32_bf16 v[148:151], v[56:59], v[24:27], v[148:151]
    ds_read_b64_tr_b16 v[126:127], v9 offset:20992
    v_mfma_f32_16x16x32_bf16 v[148:151], v[60:63], v[28:31], v[148:151]
    ds_read_b128 v[72:75], v13 offset:0
    v_mfma_f32_16x16x32_bf16 v[152:155], v[56:59], v[32:35], v[152:155]
    ds_read_b128 v[76:79], v14 offset:0
    v_mfma_f32_16x16x32_bf16 v[152:155], v[60:63], v[36:39], v[152:155]
    s_waitcnt lgkmcnt(8)
    s_nop 0
    ds_read_b128 v[80:83], v13 offset:2048
    v_mfma_f32_16x16x32_bf16 v[156:159], v[56:59], v[40:43], v[156:159]
    ds_read_b128 v[84:87], v14 offset:2048
    v_mfma_f32_16x16x32_bf16 v[156:159], v[60:63], v[44:47], v[156:159]
    ds_read_b128 v[88:91], v13 offset:4096
    v_mfma_f32_16x16x32_bf16 v[160:163], v[16:19], v[64:67], v[160:163]
    ds_read_b128 v[92:95], v14 offset:4096
    v_mfma_f32_16x16x32_bf16 v[160:163], v[20:23], v[68:71], v[160:163]
    ds_read_b128 v[96:99], v13 offset:6144
    v_mfma_f32_16x16x32_bf16 v[164:167], v[24:27], v[64:67], v[164:167]
    ds_read_b128 v[100:103], v14 offset:6144
    v_mfma_f32_16x16x32_bf16 v[164:167], v[28:31], v[68:71], v[164:167]
    v_mfma_f32_16x16x32_bf16 v[168:171], v[32:35], v[64:67], v[168:171]
    v_mfma_f32_16x16x32_bf16 v[168:171], v[36:39], v[68:71], v[168:171]
    v_mfma_f32_16x16x32_bf16 v[172:175], v[40:43], v[64:67], v[172:175]
    v_mfma_f32_16x16x32_bf16 v[172:175], v[44:47], v[68:71], v[172:175]
    s_waitcnt lgkmcnt(0)
    s_lshl_b32 s32, s6, 13
    s_add_u32 s32, s32, 16384
    v_add_u32 v13, s32, v15
    v_xor_b32 v14, 64, v13
    v_add_u32 v9, s33, v10
    s_add_u32 s6, s6, 1
    s_and_b32 s6, s6, 7
    s_add_u32 s33, s33, 24576
    s_cmp_eq_u32 s33, 73728
    s_cselect_b32 s33, 0, s33
    s_barrier
.p2align 3
    ds_read_b64_tr_b16 v[48:49], v9 offset:0
    v_mfma_f32_16x16x32_bf16 v[128:131], v[104:107], v[72:75], v[128:131]
    ds_read_b64_tr_b16 v[50:51], v9 offset:512
    v_mfma_f32_16x16x32_bf16 v[128:131], v[108:111], v[76:79], v[128:131]
    ds_read_b64_tr_b16 v[52:53], v9 offset:4096
    v_mfma_f32_16x16x32_bf16 v[132:135], v[104:107], v[80:83], v[132:135]
    ds_read_b64_tr_b16 v[54:55], v9 offset:4608
    v_mfma_f32_16x16x32_bf16 v[132:135], v[108:111], v[84:87], v[132:135]
    ds_read_b64_tr_b16 v[56:57], v9 offset:8192
    v_mfma_f32_16x16x32_bf16 v[136:139], v[104:107], v[88:91], v[136:139]
    ds_read_b64_tr_b16 v[58:59], v9 offset:8704
    v_mfma_f32_16x16x32_bf16 v[136:139], v[108:111], v[92:95], v[136:139]
    ds_read_b64_tr_b16 v[60:61], v9 offset:12288
    v_mfma_f32_16x16x32_bf16 v[140:143], v[104:107], v[96:99], v[140:143]
    ds_read_b64_tr_b16 v[62:63], v9 offset:12800
    v_mfma_f32_16x16x32_bf16 v[140:143], v[108:111], v[100:103], v[140:143]
    ds_read_b64_tr_b16 v[64:65], v9 offset:16384
    v_mfma_f32_16x16x32_bf16 v[144:147], v[112:115], v[72:75], v[144:147]
    ds_read_b64_tr_b16 v[66:67], v9 offset:16896
    v_mfma_f32_16x16x32_bf16 v[144:147], v[116:119], v[76:79], v[144:147]
    ds_read_b64_tr_b16 v[68:69], v9 offset:20480
    v_mfma_f32_16x16x32_bf16 v[148:151], v[112:115], v[80:83], v[148:151]
    ds_read_b64_tr_b16 v[70:71], v9 offset:20992
    v_mfma_f32_16x16x32_bf16 v[148:151], v[116:119], v[84:87], v[148:151]
    ds_read_b128 v[16:19], v13 offset:0
    v_mfma_f32_16x16x32_bf16 v[152:155], v[112:115], v[88:91], v[152:155]
    ds_read_b128 v[20:23], v14 offset:0
    v_mfma_f32_16x16x32_bf16 v[152:155], v[116:119], v[92:95], v[152:155]
    s_waitcnt lgkmcnt(8)
    s_nop 0
    ds_read_b128 v[24:27], v13 offset:2048
    v_mfma_f32_16x16x32_bf16 v[156:159], v[112:115], v[96:99], v[156:159]
    ds_read_b128 v[28:31], v14 offset:2048
    v_mfma_f32_16x16x32_bf16 v[156:159], v[116:119], v[100:103], v[156:159]
    ds_read_b128 v[32:35], v13 offset:4096
    v_mfma_f32_16x16x32_bf16 v[160:163], v[72:75], v[120:123], v[160:163]
    ds_read_b128 v[36:39], v14 offset:4096
    v_mfma_f32_16x16x32_bf16 v[160:163], v[76:79], v[124:127], v[160:163]
    ds_read_b128 v[40:43], v13 offset:6144
    v_mfma_f32_16x16x32_bf16 v[164:167], v[80:83], v[120:123], v[164:167]
    ds_read_b128 v[44:47], v14 offset:6144
    v_mfma_f32_16x16x32_bf16 v[164:167], v[84:87], v[124:127], v[164:167]
    v_mfma_f32_16x16x32_bf16 v[168:171], v[88:91], v[120:123], v[168:171]
    v_mfma_f32_16x16x32_bf16 v[168:171], v[92:95], v[124:127], v[168:171]
    v_mfma_f32_16x16x32_bf16 v[172:175], v[96:99], v[120:123], v[172:175]
    v_mfma_f32_16x16x32_bf16 v[172:175], v[100:103], v[124:127], v[172:175]
    s_waitcnt lgkmcnt(0)
    s_add_u32 s5, s5, 1
    s_cmp_lt_u32 s5, 3
    s_cbranch_scc1 L_QLOOP
    buffer_load_dword v5, v2, s[60:63], 0 offen sc1
    s_lshl_b32 s32, s6, 13
    s_add_u32 s32, s32, 16384
    v_add_u32 v13, s32, v15
    v_xor_b32 v14, 64, v13
    v_add_u32 v9, s33, v10
    s_add_u32 s6, s6, 1
    s_and_b32 s6, s6, 7
    s_add_u32 s33, s33, 24576
    s_cmp_eq_u32 s33, 73728
    s_cselect_b32 s33, 0, s33
    s_barrier
.p2align 3
    ds_read_b64_tr_b16 v[104:105], v9 offset:0
    v_mfma_f32_16x16x32_bf16 v[128:131], v[48:51], v[16:19], v[128:131]
    ds_read_b64_tr_b16 v[106:107], v9 offset:512
    v_mfma_f32_16x16x32_bf16 v[128:131], v[52:55], v[20:23], v[128:131]
    ds_read_b64_tr_b16 v[108:109], v9 offset:4096
    v_mfma_f32_16x16x32_bf16 v[132:135], v[48:51], v[24:27], v[132:135]
    ds_read_b64_tr_b16 v[110:111], v9 offset:4608
    v_mfma_f32_16x16x32_bf16 v[132:135], v[52:55], v[28:31], v[132:135]
    ds_read_b64_tr_b16 v[112:113], v9 offset:8192
    v_mfma_f32_16x16x32_bf16 v[136:139], v[48:51], v[32:35], v[136:139]
    ds_read_b64_tr_b16 v[114:115], v9 offset:8704
    v_mfma_f32_16x16x32_bf16 v[136:139], v[52:55], v[36:39], v[136:139]
    ds_read_b64_tr_b16 v[116:117], v9 offset:12288
    v_mfma_f32_16x16x32_bf16 v[140:143], v[48:51], v[40:43], v[140:143]
    ds_read_b64_tr_b16 v[118:119], v9 offset:12800
    v_mfma_f32_16x16x32_bf16 v[140:143], v[52:55], v[44:47], v[140:143]
    ds_read_b64_tr_b16 v[120:121], v9 offset:16384
    v_mfma_f32_16x16x32_bf16 v[144:147], v[56:59], v[16:19], v[144:147]
    ds_read_b64_tr_b16 v[122:123], v9 offset:16896
    v_mfma_f32_16x16x32_bf16 v[144:147], v[60:63], v[20:23], v[144:147]
    ds_read_b64_tr_b16 v[124:125], v9 offset:20480
    v_mfma_f32_16x16x32_bf16 v[148:151], v[56:59], v[24:27], v[148:151]
    ds_read_b64_tr_b16 v[126:127], v9 offset:20992
    v_mfma_f32_16x16x32_bf16 v[148:151], v[60:63], v[28:31], v[148:151]
    ds_read_b128 v[72:75], v13 offset:0
    v_mfma_f32_16x16x32_bf16 v[152:155], v[56:59], v[32:35], v[152:155]
    ds_read_b128 v[76:79], v14 offset:0
    v_mfma_f32_16x16x32_bf16 v[152:155], v[60:63], v[36:39], v[152:155]
    s_waitcnt lgkmcnt(8)
    s_nop 0
    ds_read_b128 v[80:83], v13 offset:2048
    v_mfma_f32_16x16x32_bf16 v[156:159], v[56:59], v[40:43], v[156:159]
    ds_read_b128 v[84:87], v14 offset:2048
    v_mfma_f32_16x16x32_bf16 v[156:159], v[60:63], v[44:47], v[156:159]
    ds_read_b128 v[88:91], v13 offset:4096
    v_mfma_f32_16x16x32_bf16 v[160:163], v[16:19], v[64:67], v[160:163]
    ds_read_b128 v[92:95], v14 offset:4096
    v_mfma_f32_16x16x32_bf16 v[160:163], v[20:23], v[68:71], v[160:163]
    ds_read_b128 v[96:99], v13 offset:6144
    v_mfma_f32_16x16x32_bf16 v[164:167], v[24:27], v[64:67], v[164:167]
    ds_read_b128 v[100:103], v14 offset:6144
    v_mfma_f32_16x16x32_bf16 v[164:167], v[28:31], v[68:71], v[164:167]
    v_mfma_f32_16x16x32_bf16 v[168:171], v[32:35], v[64:67], v[168:171]
    v_mfma_f32_16x16x32_bf16 v[168:171], v[36:39], v[68:71], v[168:171]
    v_mfma_f32_16x16x32_bf16 v[172:175], v[40:43], v[64:67], v[172:175]
    v_mfma_f32_16x16x32_bf16 v[172:175], v[44:47], v[68:71], v[172:175]
    s_waitcnt lgkmcnt(0)
    s_barrier
    v_mfma_f32_16x16x32_bf16 v[128:131], v[104:107], v[72:75], v[128:131]
    v_mfma_f32_16x16x32_bf16 v[128:131], v[108:111], v[76:79], v[128:131]
    v_mfma_f32_16x16x32_bf16 v[132:135], v[104:107], v[80:83], v[132:135]
    v_mfma_f32_16x16x32_bf16 v[132:135], v[108:111], v[84:87], v[132:135]
    v_mfma_f32_16x16x32_bf16 v[136:139], v[104:107], v[88:91], v[136:139]
    v_mfma_f32_16x16x32_bf16 v[136:139], v[108:111], v[92:95], v[136:139]
    v_mfma_f32_16x16x32_bf16 v[140:143], v[104:107], v[96:99], v[140:143]
    v_mfma_f32_16x16x32_bf16 v[140:143], v[108:111], v[100:103], v[140:143]
    v_mfma_f32_16x16x32_bf16 v[144:147], v[112:115], v[72:75], v[144:147]
    v_mfma_f32_16x16x32_bf16 v[144:147], v[116:119], v[76:79], v[144:147]
    v_mfma_f32_16x16x32_bf16 v[148:151], v[112:115], v[80:83], v[148:151]
    v_mfma_f32_16x16x32_bf16 v[148:151], v[116:119], v[84:87], v[148:151]
    v_mfma_f32_16x16x32_bf16 v[152:155], v[112:115], v[88:91], v[152:155]
    v_mfma_f32_16x16x32_bf16 v[152:155], v[116:119], v[92:95], v[152:155]
    v_mfma_f32_16x16x32_bf16 v[156:159], v[112:115], v[96:99], v[156:159]
    v_mfma_f32_16x16x32_bf16 v[156:159], v[116:119], v[100:103], v[156:159]
    v_mfma_f32_16x16x32_bf16 v[160:163], v[72:75], v[120:123], v[160:163]
    v_mfma_f32_16x16x32_bf16 v[160:163], v[76:79], v[124:127], v[160:163]
    v_mfma_f32_16x16x32_bf16 v[164:167], v[80:83], v[120:123], v[164:167]
    v_mfma_f32_16x16x32_bf16 v[164:167], v[84:87], v[124:127], v[164:167]
    v_mfma_f32_16x16x32_bf16 v[168:171], v[88:91], v[120:123], v[168:171]
    v_mfma_f32_16x16x32_bf16 v[168:171], v[92:95], v[124:127], v[168:171]
    v_mfma_f32_16x16x32_bf16 v[172:175], v[96:99], v[120:123], v[172:175]
    v_mfma_f32_16x16x32_bf16 v[172:175], v[100:103], v[124:127], v[172:175]
    s_lshl_b32 s7, s26, 2
    s_add_u32 s7, s7, s24
    s_lshl_b32 s31, s7, 16
    s_lshl_b32 s32, s25, 11
    s_add_u32 s31, s31, s32
    s_add_u32 s32, s31, 0x400000
    s_mov_b32 s20, 0x3eb8aa3b
    s_mov_b32 s21, s20
    v_pk_mul_f32 v[128:129], v[128:129], s[20:21]
    v_pk_mul_f32 v[130:131], v[130:131], s[20:21]
    v_cvt_pk_bf16_f32 v186, v144, v145
    v_cvt_pk_bf16_f32 v187, v146, v147
    v_cvt_pk_bf16_f32 v184, v128, v129
    v_cvt_pk_bf16_f32 v185, v130, v131
    s_nop 1
    v_permlane16_swap_b32 v184, v186
    v_permlane16_swap_b32 v185, v187
    buffer_store_dwordx4 v[184:187], v182, s[16:19], s31 offen offset:0 sc1
    v_pk_mul_f32 v[132:133], v[132:133], s[20:21]
    v_pk_mul_f32 v[134:135], v[134:135], s[20:21]
    v_cvt_pk_bf16_f32 v190, v148, v149
    v_cvt_pk_bf16_f32 v191, v150, v151
    v_cvt_pk_bf16_f32 v188, v132, v133
    v_cvt_pk_bf16_f32 v189, v134, v135
    s_nop 1
    v_permlane16_swap_b32 v188, v190
    v_permlane16_swap_b32 v189, v191
    buffer_store_dwordx4 v[188:191], v182, s[16:19], s31 offen offset:256 sc1
    v_pk_mul_f32 v[136:137], v[136:137], s[20:21]
    v_pk_mul_f32 v[138:139], v[138:139], s[20:21]
    v_cvt_pk_bf16_f32 v194, v152, v153
    v_cvt_pk_bf16_f32 v195, v154, v155
    v_cvt_pk_bf16_f32 v192, v136, v137
    v_cvt_pk_bf16_f32 v193, v138, v139
    s_nop 1
    v_permlane16_swap_b32 v192, v194
    v_permlane16_swap_b32 v193, v195
    buffer_store_dwordx4 v[192:195], v182, s[16:19], s31 offen offset:1024 sc1
    v_pk_mul_f32 v[140:141], v[140:141], s[20:21]
    v_pk_mul_f32 v[142:143], v[142:143], s[20:21]
    v_cvt_pk_bf16_f32 v198, v156, v157
    v_cvt_pk_bf16_f32 v199, v158, v159
    v_cvt_pk_bf16_f32 v196, v140, v141
    v_cvt_pk_bf16_f32 v197, v142, v143
    s_nop 1
    v_permlane16_swap_b32 v196, v198
    v_permlane16_swap_b32 v197, v199
    buffer_store_dwordx4 v[196:199], v182, s[16:19], s31 offen offset:1280 sc1
    v_cvt_pk_bf16_f32 v200, v160, v161
    v_cvt_pk_bf16_f32 v201, v162, v163
    v_cvt_pk_bf16_f32 v202, v164, v165
    v_cvt_pk_bf16_f32 v203, v166, v167
    s_nop 1
    v_permlane16_swap_b32 v200, v202
    v_permlane16_swap_b32 v201, v203
    buffer_store_dwordx4 v[200:203], v183, s[16:19], s32 offen offset:0 sc1
    v_cvt_pk_bf16_f32 v204, v168, v169
    v_cvt_pk_bf16_f32 v205, v170, v171
    v_cvt_pk_bf16_f32 v206, v172, v173
    v_cvt_pk_bf16_f32 v207, v174, v175
    s_nop 1
    v_permlane16_swap_b32 v204, v206
    v_permlane16_swap_b32 v205, v207
    buffer_store_dwordx4 v[204:207], v183, s[16:19], s32 offen offset:1024 sc1
    s_lshl_b32 s21, s7, 7
    s_lshl_b32 s32, s25, 2
    s_add_u32 s21, s21, s32
    s_add_u32 s21, s21, 0x1692000
    s_and_b32 s25, s3, 1
    s_xor_b32 s25, s25, 1
    s_lshl_b32 s25, s25, 2
    s_lshr_b32 s5, s3, 1
    s_add_u32 s25, s25, s5
    s_lshl_b32 s25, s25, 2
    s_lshr_b32 s5, s2, 6
    s_add_u32 s25, s25, s5
    s_bfe_u32 s26, s2, 0x30003
    s_lshl_b32 s7, s26, 2
    s_add_u32 s7, s7, s24
    v_mov_b32 v148, 0xdddddddd
    v_mov_b64 v[132:133], 0
    v_mov_b64 v[134:135], 0
    v_mov_b64 v[136:137], 0
    v_mov_b64 v[138:139], 0
    v_mov_b64 v[140:141], 0
    v_mov_b64 v[142:143], 0
    v_mov_b64 v[144:145], 0
    v_mov_b64 v[146:147], 0
    s_mov_b32 exec_lo, 0x00110000
    s_mov_b32 exec_hi, 0x00110000
    v_mov_b32 v6, 0x3f803f80
    v_mov_b32 v7, 0x3f803f80
    v_mov_b64 v[132:133], v[6:7]
    v_mov_b64 v[134:135], v[6:7]
    v_mov_b64 v[136:137], v[6:7]
    v_mov_b64 v[138:139], v[6:7]
    v_mov_b64 v[140:141], v[6:7]
    v_mov_b64 v[142:143], v[6:7]
    v_mov_b64 v[144:145], v[6:7]
    v_mov_b64 v[146:147], v[6:7]
    s_mov_b64 exec, -1
    s_mov_b32 s22, 0x0000ffff
    s_mov_b32 s23, 0x0000ffff
    v_and_b32 v8, 15, v1
    v_lshlrev_b32 v8, 4, v8
    v_lshrrev_b32 v9, 5, v1
    v_lshl_add_u32 v8, v9, 8, v8
    v_add_u32 v12, 0x2000, v8
    v_mov_b64 v[48:49], 0
    v_mov_b64 v[50:51], 0
    v_mov_b64 v[52:53], 0
    v_mov_b64 v[54:55], 0
    v_mov_b64 v[56:57], 0
    v_mov_b64 v[58:59], 0
    v_mov_b64 v[60:61], 0
    v_mov_b64 v[62:63], 0
    v_mov_b64 v[64:65], 0
    v_mov_b64 v[66:67], 0
    v_mov_b64 v[68:69], 0
    v_mov_b64 v[70:71], 0
    v_mov_b64 v[72:73], 0
    v_mov_b64 v[74:75], 0
    v_mov_b64 v[76:77], 0
    v_mov_b64 v[78:79], 0
    v_mov_b32 v149, v4
    v_mov_b32 v150, v12
    v_mov_b32 v151, 0
    v_mov_b32 v13, s24
    s_mov_b32 s9, 0x76123450
    s_lshl_b32 s28, s25, 16
    s_lshl_b32 s29, s7, 11
    s_add_u32 s29, s29, s28
    s_add_u32 s28, s28, 0x200000
    s_lshl_b32 s33, s24, 11
    s_add_u32 s30, s28, s33
    s_add_u32 s31, s30, 0x200000
    s_mov_b32 s20, 0
    s_mov_b32 s6, 6
    s_mov_b32 s15, 0x1010101
    s_mov_b32 s3, 0xc3
    s_mov_b32 s10, 4
    v_and_b32 v18, 31, v1
    v_lshlrev_b32 v18, 2, v18
    s_waitcnt vmcnt(6)
    v_readfirstlane_b32 s27, v5
    s_mov_b32 s34, 0
NG_1:
    s_cmp_lg_u32 s27, 0
    s_cbranch_scc1 NG_1_x
    s_add_u32 s34, s34, 1
    s_cmp_ge_u32 s34, 16384
    s_cbranch_scc1 NG_1_x
    buffer_load_dword v5, v2, s[60:63], 0 offen sc1
    s_waitcnt vmcnt(0)
    v_readfirstlane_b32 s27, v5
    s_branch NG_1
NG_1_x:
    s_waitcnt vmcnt(0)
    v_mov_b32 v17, s27
    s_mov_b64 exec, 1
    buffer_store_dword v17, v2, s[16:19], s21 offen sc1
    s_mov_b64 exec, -1
    ds_write_b8 v13, v3 offset:24
    s_lshl_b32 s21, s25, 7
    s_add_u32 s21, s21, 0x1692000
    s_mov_b32 s34, 0
PL_2:
    buffer_load_dword v20, v18, s[16:19], s21 offen sc1
    s_waitcnt vmcnt(0)
    v_xor_b32 v20, s27, v20
    v_cmp_ne_u32 vcc, 0, v20
    s_add_u32 s34, s34, 1
    s_cmp_ge_u32 s34, 16384
    s_cbranch_scc1 PL_2_x
    s_cbranch_vccz PL_2_x
    s_sleep 3
    s_branch PL_2
PL_2_x:
    buffer_load_dwordx4 v[128:131], v4, s[16:19], s28 offen sc1
    buffer_load_dwordx4 v[112:115], v4, s[16:19], s29 offen sc1
    buffer_load_dwordx4 v[116:119], v4, s[16:19], s29 offen offset:1024 sc1
    s_cmp_eq_u32 s24, 0
    s_cselect_b32 s32, 1024, 0
    s_add_u32 m0, s33, s32
    s_add_u32 s32, s32, s30
    buffer_load_dwordx4 v4, s[16:19], s32 offen sc1 lds
    s_mov_b32 m0, s33
    s_mov_b32 s11, s33
    s_mov_b32 s32, 0
    s_mov_b32 s35, s30
    buffer_load_dwordx4 v4, s[16:19], s35 offen offset:1024 sc1 lds
    s_add_u32 m0, s11, 8192
    s_add_u32 s35, s31, s32
    buffer_load_dwordx4 v4, s[16:19], s35 offen sc1 lds
    buffer_load_dwordx4 v4, s[16:19], s35 offen offset:1024 sc1 lds
    s_lshl_b32 s28, s7, 7
    s_add_u32 s28, s28, 0x1691000
    s_waitcnt vmcnt(4)
    v_mfma_f32_32x32x16_bf16 v[16:31], v[128:131], v[112:115], 0
    v_mfma_f32_32x32x16_bf16 v[32:47], v[128:131], v[116:119], 0
    s_bfe_u32 s32, s9, 0x30004
    s_lshl_b32 s11, s32, 14
    s_add_u32 s11, s11, s33
    s_mov_b32 m0, s11
    s_lshl_b32 s32, s32, 13
    s_add_u32 s35, s30, s32
    buffer_load_dwordx4 v4, s[16:19], s35 offen sc1 lds
    buffer_load_dwordx4 v4, s[16:19], s35 offen offset:1024 sc1 lds
    s_add_u32 m0, s11, 8192
    s_add_u32 s35, s31, s32
    buffer_load_dwordx4 v4, s[16:19], s35 offen sc1 lds
    buffer_load_dwordx4 v4, s[16:19], s35 offen offset:1024 sc1 lds
    s_waitcnt vmcnt(4)
    ds_write_b8 v13, v3 offset:32
    v_max3_f32 v6, v16, v17, v18
    v_max3_f32 v6, v6, v19, v20
    v_max3_f32 v6, v6, v21, v22
    v_max3_f32 v6, v6, v23, v24
    v_max3_f32 v6, v6, v25, v26
    v_max3_f32 v6, v6, v27, v28
    v_max3_f32 v6, v6, v29, v30
    v_max_f32 v6, v6, v31
    v_max3_f32 v8, v32, v33, v34
    v_max3_f32 v8, v8, v35, v36
    v_max3_f32 v8, v8, v37, v38
    v_max3_f32 v8, v8, v39, v40
    v_max3_f32 v8, v8, v41, v42
    v_max3_f32 v8, v8, v43, v44
    v_max3_f32 v8, v8, v45, v46
    v_max_f32 v8, v8, v47
L_SETMAX:
    v_mov_b32 v7, v6
    v_mov_b32 v9, v8
    s_nop 1
    v_permlane32_swap_b32 v6, v7
    v_permlane32_swap_b32 v8, v9
    s_nop 1
    v_max_f32 v6, v6, v7
    v_max_f32 v8, v8, v9
    v_sub_f32 v6, 0, v6
    v_sub_f32 v8, 0, v8
    v_mov_b32 v7, v6
    v_mov_b32 v9, v8
    v_mov_b64 v[80:81], v[6:7]
    v_mov_b64 v[82:83], v[6:7]
    v_mov_b64 v[84:85], v[6:7]
    v_mov_b64 v[86:87], v[6:7]
    v_mov_b64 v[88:89], v[6:7]
    v_mov_b64 v[90:91], v[6:7]
    v_mov_b64 v[92:93], v[6:7]
    v_mov_b64 v[94:95], v[6:7]
    v_mov_b64 v[120:121], v[128:129]
    v_mov_b64 v[122:123], v[130:131]
    v_mfma_f32_32x32x16_bf16 v[16:31], v[128:131], v[112:115], v[80:95]
    v_mov_b64 v[96:97], v[8:9]
    v_mov_b64 v[98:99], v[8:9]
    v_mov_b64 v[100:101], v[8:9]
    v_mov_b64 v[102:103], v[8:9]
    v_mov_b64 v[104:105], v[8:9]
    v_mov_b64 v[106:107], v[8:9]
    v_mov_b64 v[108:109], v[8:9]
    v_mov_b64 v[110:111], v[8:9]
    v_mov_b64 v[40:41], 0
    v_mov_b64 v[42:43], 0
    v_mov_b64 v[44:45], 0
    v_mov_b64 v[46:47], 0
    s_mov_b32 s34, 0
LW_3:
    ds_read_b32 v5, v2 offset:32
    s_waitcnt lgkmcnt(0)
    v_readfirstlane_b32 s35, v5
    s_add_u32 s34, s34, 1
    s_cmp_ge_u32 s34, 131072
    s_cbranch_scc1 LW_3_x
    s_cmp_lt_u32 s35, 16843009
    s_cbranch_scc1 LW_3
LW_3_x:
    s_mov_b64 exec, s[22:23]
    ds_read_b128 v[132:135], v150
    ds_read_b128 v[136:139], v150 offset:512
    s_mov_b64 exec, -1
    ds_read_b128 v[124:127], v149 offset:1024
    s_waitcnt lgkmcnt(0)
    s_setprio 1
    s_mov_b32 s5, 0
.p2align 3
L_ALOOP:
    v_exp_f32 v16, v16
    v_exp_f32 v17, v17
    v_smfmac_f32_32x32x32_bf16 v[64:79], v[144:147], v[40:47], v148
    s_mov_b64 exec, s[22:23]
    s_lshr_b32 s9, s9, 4
    ds_read_b128 v[140:143], v150 offset:1024
    ds_read_b128 v[144:147], v150 offset:1536
    s_mov_b64 exec, -1
    v_exp_f32 v18, v18
    v_exp_f32 v19, v19
    v_exp_f32 v20, v20
    v_mfma_f32_32x32x16_bf16 v[32:47], v[120:123], v[116:119], v[96:111]
    s_bfe_u32 s12, s9, 0x30004
    v_exp_f32 v21, v21
    v_exp_f32 v22, v22
    v_exp_f32 v23, v23
    v_exp_f32 v24, v24
    v_exp_f32 v25, v25
    v_exp_f32 v26, v26
    v_smfmac_f32_32x32x32_bf16 v[48:63], v[132:135], v[16:23], v148
    s_nop 0
    v_exp_f32 v27, v27
    v_exp_f32 v28, v28
    v_exp_f32 v29, v29
    v_exp_f32 v30, v30
    v_exp_f32 v31, v31
    v_exp_f32 v32, v32
    v_exp_f32 v33, v33
    v_smfmac_f32_32x32x32_bf16 v[48:63], v[136:139], v[24:31], v148
    s_waitcnt lgkmcnt(2)
    v_exp_f32 v34, v34
    v_exp_f32 v35, v35
    v_exp_f32 v36, v36
    v_mfma_f32_32x32x16_bf16 v[16:31], v[124:127], v[112:115], v[80:95]
    v_exp_f32 v37, v37
    v_exp_f32 v38, v38
    v_exp_f32 v39, v39
    v_exp_f32 v40, v40
    v_exp_f32 v41, v41
    v_exp_f32 v42, v42
    v_smfmac_f32_32x32x32_bf16 v[64:79], v[132:135], v[32:39], v148
    s_waitcnt lgkmcnt(0)
    s_nop 0
    ds_read_b128 v[120:123], v149 offset:2048
    v_exp_f32_e64 v43, v43
    v_exp_f32 v44, v44
    v_exp_f32 v45, v45
    v_exp_f32 v46, v46
    v_exp_f32 v47, v47
    v_exp_f32 v16, v16
    v_exp_f32 v17, v17
    v_smfmac_f32_32x32x32_bf16 v[64:79], v[136:139], v[40:47], v148
    s_mov_b64 exec, s[22:23]
    s_and_b32 s8, s9, 7
    ds_read_b128 v[132:135], v150 offset:2048
    ds_read_b128 v[136:139], v150 offset:2560
    s_mov_b64 exec, -1
    v_exp_f32 v18, v18
    v_exp_f32 v19, v19
    v_exp_f32 v20, v20
    v_mfma_f32_32x32x16_bf16 v[32:47], v[124:127], v[116:119], v[96:111]
    v_exp_f32 v21, v21
    v_exp_f32 v22, v22
    v_exp_f32 v23, v23
    v_exp_f32 v24, v24
    v_exp_f32 v25, v25
    v_exp_f32 v26, v26
    v_smfmac_f32_32x32x32_bf16 v[48:63], v[140:143], v[16:23], v148
    s_lshl_b32 s11, s12, 14
    v_exp_f32 v27, v27
    v_exp_f32 v28, v28
    v_exp_f32 v29, v29
    v_exp_f32 v30, v30
    v_exp_f32 v31, v31
    v_exp_f32 v32, v32
    v_exp_f32 v33, v33
    v_smfmac_f32_32x32x32_bf16 v[48:63], v[144:147], v[24:31], v148
    s_waitcnt lgkmcnt(2)
    v_exp_f32 v34, v34
    v_exp_f32 v35, v35
    v_exp_f32 v36, v36
    v_mfma_f32_32x32x16_bf16 v[16:31], v[120:123], v[112:115], v[80:95]
    v_exp_f32 v37, v37
    v_exp_f32 v38, v38
    v_exp_f32 v39, v39
    v_exp_f32 v40, v40
    v_exp_f32 v41, v41
    v_exp_f32 v42, v42
    v_smfmac_f32_32x32x32_bf16 v[64:79], v[140:143], v[32:39], v148
    s_waitcnt lgkmcnt(0)
    s_nop 0
    ds_read_b128 v[124:127], v149 offset:3072
    v_exp_f32_e64 v43, v43
    v_exp_f32 v44, v44
    v_exp_f32 v45, v45
    v_exp_f32 v46, v46
    v_exp_f32 v47, v47
    v_exp_f32 v16, v16
    v_exp_f32 v17, v17
    v_smfmac_f32_32x32x32_bf16 v[64:79], v[144:147], v[40:47], v148
    s_mov_b64 exec, s[22:23]
    s_lshl_b32 s8, s8, 14
    ds_read_b128 v[140:143], v150 offset:3072
    ds_read_b128 v[144:147], v150 offset:3584
    s_mov_b64 exec, -1
    v_exp_f32 v18, v18
    v_exp_f32 v19, v19
    v_exp_f32 v20, v20
    v_mfma_f32_32x32x16_bf16 v[32:47], v[120:123], v[116:119], v[96:111]
    v_exp_f32 v21, v21
    v_exp_f32 v22, v22
    v_exp_f32 v23, v23
    v_exp_f32 v24, v24
    v_exp_f32 v25, v25
    v_exp_f32 v26, v26
    v_smfmac_f32_32x32x32_bf16 v[48:63], v[132:135], v[16:23], v148
    s_waitcnt vmcnt(0)
    s_bitcmp1_b32 s10, s5
    ds_write_b8 v13, v3 offset:36
    v_exp_f32_e64 v27, v27
    v_exp_f32 v28, v28
    v_exp_f32 v29, v29
    v_exp_f32 v30, v30
    v_exp_f32 v31, v31
    v_exp_f32 v32, v32
    v_exp_f32 v33, v33
    v_smfmac_f32_32x32x32_bf16 v[48:63], v[136:139], v[24:31], v148
    s_waitcnt lgkmcnt(3)
    s_cbranch_scc1 L_TA
L_NOG:
    v_exp_f32_e64 v34, v34
    v_exp_f32 v35, v35
    v_exp_f32 v36, v36
    v_mfma_f32_32x32x16_bf16 v[16:31], v[124:127], v[112:115], v[80:95]
    v_exp_f32 v37, v37
    v_exp_f32 v38, v38
    v_exp_f32 v39, v39
    v_exp_f32 v40, v40
    v_exp_f32 v41, v41
    v_exp_f32 v42, v42
    v_smfmac_f32_32x32x32_bf16 v[64:79], v[132:135], v[32:39], v148
    s_waitcnt lgkmcnt(0)
    s_nop 0
    ds_read_b128 v[120:123], v149 offset:4096
    v_exp_f32_e64 v43, v43
    v_exp_f32 v44, v44
    v_exp_f32 v45, v45
    v_exp_f32 v46, v46
    v_exp_f32 v47, v47
    v_exp_f32 v16, v16
    v_exp_f32 v17, v17
    v_smfmac_f32_32x32x32_bf16 v[64:79], v[136:139], v[40:47], v148
    s_mov_b64 exec, s[22:23]
    s_lshl_b32 s14, s12, 13
    ds_read_b128 v[132:135], v150 offset:4096
    ds_read_b128 v[136:139], v150 offset:4608
    s_mov_b64 exec, -1
    v_exp_f32 v18, v18
    v_exp_f32 v19, v19
    v_exp_f32 v20, v20
    v_mfma_f32_32x32x16_bf16 v[32:47], v[124:127], v[116:119], v[96:111]
    v_exp_f32 v21, v21
    v_exp_f32 v22, v22
    v_exp_f32 v23, v23
    v_exp_f32 v24, v24
    v_exp_f32 v25, v25
    v_exp_f32 v26, v26
    v_smfmac_f32_32x32x32_bf16 v[48:63], v[140:143], v[16:23], v148
    s_add_u32 s11, s11, s33
    v_exp_f32 v27, v27
    v_exp_f32 v28, v28
    v_exp_f32 v29, v29
    v_exp_f32 v30, v30
    v_exp_f32 v31, v31
    v_exp_f32 v32, v32
    v_exp_f32 v33, v33
    v_smfmac_f32_32x32x32_bf16 v[48:63], v[144:147], v[24:31], v148
    s_waitcnt lgkmcnt(2)
    v_exp_f32 v34, v34
    v_exp_f32 v35, v35
    v_exp_f32 v36, v36
    v_mfma_f32_32x32x16_bf16 v[16:31], v[120:123], v[112:115], v[80:95]
    v_exp_f32 v37, v37
    v_exp_f32 v38, v38
    v_exp_f32 v39, v39
    v_exp_f32 v40, v40
    v_exp_f32 v41, v41
    v_exp_f32 v42, v42
    v_smfmac_f32_32x32x32_bf16 v[64:79], v[140:143], v[32:39], v148
    s_waitcnt lgkmcnt(0)
    s_nop 0
    ds_read_b128 v[124:127], v149 offset:5120
    v_exp_f32_e64 v43, v43
    v_exp_f32 v44, v44
    v_exp_f32 v45, v45
    v_exp_f32 v46, v46
    v_exp_f32 v47, v47
    v_exp_f32 v16, v16
    v_exp_f32 v17, v17
    v_smfmac_f32_32x32x32_bf16 v[64:79], v[144:147], v[40:47], v148
    s_mov_b64 exec, s[22:23]
    s_add_u32 s13, s30, s14
    ds_read_b128 v[140:143], v150 offset:5120
    ds_read_b128 v[144:147], v150 offset:5632
    s_mov_b64 exec, -1
    v_exp_f32 v18, v18
    v_exp_f32 v19, v19
    v_exp_f32 v20, v20
    v_mfma_f32_32x32x16_bf16 v[32:47], v[120:123], v[116:119], v[96:111]
    v_exp_f32 v21, v21
    v_exp_f32 v22, v22
    v_exp_f32 v23, v23
    v_exp_f32 v24, v24
    v_exp_f32 v25, v25
    v_exp_f32 v26, v26
    v_smfmac_f32_32x32x32_bf16 v[48:63], v[132:135], v[16:23], v148
    s_add_u32 s14, s31, s14
    v_exp_f32 v27, v27
    v_exp_f32 v28, v28
    v_exp_f32 v29, v29
    v_exp_f32 v30, v30
    v_exp_f32 v31, v31
    v_exp_f32 v32, v32
    v_exp_f32 v33, v33
    v_smfmac_f32_32x32x32_bf16 v[48:63], v[136:139], v[24:31], v148
    s_waitcnt lgkmcnt(2)
    v_exp_f32 v34, v34
    v_exp_f32 v35, v35
    v_exp_f32 v36, v36
    v_mfma_f32_32x32x16_bf16 v[16:31], v[124:127], v[112:115], v[80:95]
    v_exp_f32 v37, v37
    v_exp_f32 v38, v38
    v_exp_f32 v39, v39
    v_exp_f32 v40, v40
    v_exp_f32 v41, v41
    v_exp_f32 v42, v42
    v_smfmac_f32_32x32x32_bf16 v[64:79], v[132:135], v[32:39], v148
    s_waitcnt lgkmcnt(0)
    s_nop 0
    ds_read_b128 v[120:123], v149 offset:6144
    v_exp_f32_e64 v43, v43
    v_exp_f32 v44, v44
    v_exp_f32 v45, v45
    v_exp_f32 v46, v46
    v_exp_f32 v47, v47
    v_exp_f32 v16, v16
    v_exp_f32 v17, v17
    v_smfmac_f32_32x32x32_bf16 v[64:79], v[136:139], v[40:47], v148
    s_mov_b64 exec, s[22:23]
    s_mov_b32 m0, s11
    ds_read_b128 v[132:135], v150 offset:6144
    ds_read_b128 v[136:139], v150 offset:6656
    s_mov_b64 exec, -1
    v_exp_f32 v18, v18
    v_exp_f32 v19, v19
    v_exp_f32 v20, v20
    v_mfma_f32_32x32x16_bf16 v[32:47], v[124:127], v[116:119], v[96:111]
    v_exp_f32 v21, v21
    v_exp_f32 v22, v22
    v_exp_f32 v23, v23
    v_exp_f32 v24, v24
    v_exp_f32 v25, v25
    v_exp_f32 v26, v26
    v_smfmac_f32_32x32x32_bf16 v[48:63], v[140:143], v[16:23], v148
    s_bitcmp1_b32 s3, s5
    s_cbranch_scc1 L_TD
L_XFREE:
    buffer_load_dwordx4 v4, s[16:19], s13 offen sc1 lds
    buffer_load_dwordx4 v4, s[16:19], s13 offen offset:1024 sc1 lds
    s_add_u32 m0, s11, 8192
    v_exp_f32 v27, v27
    v_exp_f32 v28, v28
    buffer_load_dwordx4 v4, s[16:19], s14 offen sc1 lds
    buffer_load_dwordx4 v4, s[16:19], s14 offen offset:1024 sc1 lds
L_NODMA:
    v_exp_f32_e64 v29, v29
    v_exp_f32 v30, v30
    v_exp_f32 v31, v31
    v_exp_f32 v32, v32
    v_exp_f32 v33, v33
    v_smfmac_f32_32x32x32_bf16 v[48:63], v[144:147], v[24:31], v148
    s_waitcnt lgkmcnt(2)
    v_exp_f32 v34, v34
    v_exp_f32 v35, v35
    v_exp_f32 v36, v36
    v_mfma_f32_32x32x16_bf16 v[16:31], v[120:123], v[112:115], v[80:95]
    v_exp_f32 v37, v37
    v_exp_f32 v38, v38
    v_exp_f32 v39, v39
    v_exp_f32 v40, v40
    v_exp_f32 v41, v41
    v_exp_f32 v42, v42
    v_smfmac_f32_32x32x32_bf16 v[64:79], v[140:143], v[32:39], v148
    s_waitcnt lgkmcnt(0)
    s_nop 0
    ds_read_b128 v[124:127], v149 offset:7168
    ds_read_b32 v5, v151 offset:36
    v_exp_f32_e64 v43, v43
    v_exp_f32 v44, v44
    v_exp_f32 v45, v45
    v_exp_f32 v46, v46
    v_exp_f32 v47, v47
    v_exp_f32 v16, v16
    v_exp_f32 v17, v17
    v_smfmac_f32_32x32x32_bf16 v[64:79], v[144:147], v[40:47], v148
    s_mov_b64 exec, s[22:23]
    s_nop 0
    ds_read_b128 v[140:143], v150 offset:7168
    ds_read_b128 v[144:147], v150 offset:7680
    s_mov_b64 exec, -1
    v_exp_f32 v18, v18
    v_exp_f32 v19, v19
    v_exp_f32 v20, v20
    v_mfma_f32_32x32x16_bf16 v[32:47], v[120:123], v[116:119], v[96:111]
    v_exp_f32 v21, v21
    v_exp_f32 v22, v22
    v_exp_f32 v23, v23
    v_exp_f32 v24, v24
    v_exp_f32 v25, v25
    v_exp_f32 v26, v26
    v_smfmac_f32_32x32x32_bf16 v[48:63], v[132:135], v[16:23], v148
    s_nop 0
    v_exp_f32 v27, v27
    v_exp_f32 v28, v28
    v_exp_f32 v29, v29
    v_exp_f32 v30, v30
    v_exp_f32 v31, v31
    v_exp_f32 v32, v32
    v_exp_f32 v33, v33
    v_smfmac_f32_32x32x32_bf16 v[48:63], v[136:139], v[24:31], v148
    s_waitcnt lgkmcnt(2)
    v_exp_f32 v34, v34
    v_exp_f32 v35, v35
    v_exp_f32 v36, v36
    v_mfma_f32_32x32x16_bf16 v[16:31], v[124:127], v[112:115], v[80:95]
    v_cmp_ne_u32_e64 vcc, s15, v5
    v_add_u32 v149, s8, v4
    v_add_u32 v150, s8, v12
    v_exp_f32 v37, v37
    v_exp_f32 v38, v38
    v_exp_f32 v39, v39
    v_exp_f32 v40, v40
    v_exp_f32 v41, v41
    v_exp_f32 v42, v42
    v_smfmac_f32_32x32x32_bf16 v[64:79], v[132:135], v[32:39], v148
    s_waitcnt lgkmcnt(0)
    s_cbranch_vccnz L_KVWAIT
L_KVOK:
    ds_read_b128 v[120:123], v149 offset:0
    v_exp_f32_e64 v43, v43
    v_exp_f32 v44, v44
    v_exp_f32 v45, v45
    v_exp_f32 v46, v46
    v_exp_f32 v47, v47
    v_exp_f32 v16, v16
    v_exp_f32 v17, v17
    v_smfmac_f32_32x32x32_bf16 v[64:79], v[136:139], v[40:47], v148
    s_mov_b64 exec, s[22:23]
    s_add_u32 s5, s5, 1
    ds_read_b128 v[132:135], v150 offset:0
    ds_read_b128 v[136:139], v150 offset:512
    s_mov_b64 exec, -1
    v_exp_f32 v18, v18
    v_exp_f32 v19, v19
    v_exp_f32 v20, v20
    v_mfma_f32_32x32x16_bf16 v[32:47], v[124:127], v[116:119], v[96:111]
    v_exp_f32 v21, v21
    v_exp_f32 v22, v22
    v_exp_f32 v23, v23
    v_exp_f32 v24, v24
    v_exp_f32 v25, v25
    v_exp_f32 v26, v26
    v_smfmac_f32_32x32x32_bf16 v[48:63], v[140:143], v[16:23], v148
    s_nop 0
    v_exp_f32 v27, v27
    v_exp_f32 v28, v28
    v_exp_f32 v29, v29
    v_exp_f32 v30, v30
    v_exp_f32 v31, v31
    v_exp_f32 v32, v32
    v_exp_f32 v33, v33
    v_smfmac_f32_32x32x32_bf16 v[48:63], v[144:147], v[24:31], v148
    s_waitcnt lgkmcnt(2)
    v_exp_f32 v34, v34
    v_exp_f32 v35, v35
    v_exp_f32 v36, v36
    v_mfma_f32_32x32x16_bf16 v[16:31], v[120:123], v[112:115], v[80:95]
    v_add_u32 v13, 4, v13
    v_add_u32 v151, 4, v151
    v_exp_f32 v37, v37
    v_exp_f32 v38, v38
    v_exp_f32 v39, v39
    v_exp_f32 v40, v40
    v_exp_f32 v41, v41
    v_exp_f32 v42, v42
    v_smfmac_f32_32x32x32_bf16 v[64:79], v[140:143], v[32:39], v148
    s_waitcnt lgkmcnt(0)
    s_cmp_lt_u32 s5, 8
    ds_read_b128 v[124:127], v149 offset:1024
    v_exp_f32 v43, v43
    v_exp_f32 v44, v44
    v_exp_f32 v45, v45
    v_exp_f32 v46, v46
    v_exp_f32 v47, v47
    s_cbranch_scc1 L_ALOOP
    s_nop 0
    v_smfmac_f32_32x32x32_bf16 v[64:79], v[144:147], v[40:47], v148
    s_setprio 3
L_AJOIN:
    s_lshl_b32 s32, s24, 2
    v_mov_b32 v5, s32
    ds_write_b32 v5, v3 offset:96
.p2align 3
    v_add_f32 v5, abs(v56), abs(v48)
    v_add_f32 v5, v5, abs(v49)
    v_add_f32 v5, v5, abs(v50)
    v_add_f32 v5, v5, abs(v51)
    v_add_f32 v5, v5, abs(v52)
    v_add_f32 v5, v5, abs(v53)
    v_add_f32 v5, v5, abs(v54)
    v_add_f32 v5, v5, abs(v55)
    v_rcp_f32 v8, v56
    s_nop 0
    v_mul_f32 v8, v8, v10
    s_nop 0
    v_pk_mul_f32 v[160:161], v[48:49], v[8:9] op_sel_hi:[1,0]
    v_pk_mul_f32 v[162:163], v[50:51], v[8:9] op_sel_hi:[1,0]
    v_pk_mul_f32 v[164:165], v[52:53], v[8:9] op_sel_hi:[1,0]
    v_pk_mul_f32 v[166:167], v[54:55], v[8:9] op_sel_hi:[1,0]
    v_cvt_pk_bf16_f32 v152, v160, v161
    v_cvt_pk_bf16_f32 v153, v162, v163
    v_cvt_pk_bf16_f32 v154, v164, v165
    v_cvt_pk_bf16_f32 v155, v166, v167
    v_min_u32 v152, -2, v152
    v_min_u32 v153, -2, v153
    v_min_u32 v154, -2, v154
    v_min_u32 v155, -2, v155
    v_add_f32 v5, v5, abs(v64)
    v_add_f32 v5, v5, abs(v65)
    v_add_f32 v5, v5, abs(v66)
    v_add_f32 v5, v5, abs(v67)
    v_add_f32 v5, v5, abs(v68)
    v_add_f32 v5, v5, abs(v69)
    v_add_f32 v5, v5, abs(v70)
    v_add_f32 v5, v5, abs(v71)
    v_add_f32 v5, v5, abs(v72)
    v_mov_b32 v6, 0x207
    v_cmp_class_f32 vcc, v5, v6
    v_rcp_f32 v8, v72
    s_nop 0
    v_mul_f32 v8, v8, v11
    s_nop 0
    v_pk_mul_f32 v[160:161], v[64:65], v[8:9] op_sel_hi:[1,0]
    v_pk_mul_f32 v[162:163], v[66:67], v[8:9] op_sel_hi:[1,0]
    v_pk_mul_f32 v[164:165], v[68:69], v[8:9] op_sel_hi:[1,0]
    v_pk_mul_f32 v[166:167], v[70:71], v[8:9] op_sel_hi:[1,0]
    v_cvt_pk_bf16_f32 v156, v160, v161
    v_cvt_pk_bf16_f32 v157, v162, v163
    v_cvt_pk_bf16_f32 v158, v164, v165
    v_cvt_pk_bf16_f32 v159, v166, v167
    v_min_u32 v156, -2, v156
    v_min_u32 v157, -2, v157
    v_min_u32 v158, -2, v158
    v_min_u32 v159, -2, v159
    s_cmp_lg_u32 s20, 0
    s_cbranch_scc1 L_AFIN
    s_cbranch_vccnz L_REDO
L_AFIN:
    buffer_store_dwordx4 v[152:155], v14, s[16:19], s21 offen offset:0 sc1
    buffer_store_dwordx4 v[156:159], v14, s[16:19], s21 offen offset:2048 sc1
    s_barrier
    s_barrier
    s_branch L_FIN
L_TD:
    s_cmp_lt_u32 s5, s6
    s_cbranch_scc1 L_TD0
    v_exp_f32 v27, v27
    v_exp_f32 v28, v28
    s_branch L_NODMA
L_TD0:
    s_cmp_lg_u32 s5, 0
    s_cbranch_scc1 L_TD1
    s_mov_b32 s34, 0
LW_4:
    ds_read_b32 v5, v2 offset:0
    s_waitcnt lgkmcnt(0)
    v_readfirstlane_b32 s35, v5
    s_add_u32 s34, s34, 1
    s_cmp_ge_u32 s34, 131072
    s_cbranch_scc1 LW_4_x
    s_cmp_lt_u32 s35, 4
    s_cbranch_scc1 LW_4
LW_4_x:
    s_branch L_XFREE
L_TD1:
    buffer_load_dword v10, v2, s[16:19], s28 offen sc1
    v_and_b32 v14, 15, v1
    v_lshlrev_b32 v14, 4, v14
    v_bfe_u32 v8, v1, 4, 1
    v_lshl_add_u32 v14, v8, 10, v14
    v_lshrrev_b32 v8, 5, v1
    v_lshl_add_u32 v14, v8, 8, v14
    s_mul_i32 s21, s7, 44
    s_lshr_b32 s32, s25, 1
    s_add_u32 s21, s21, s32
    s_add_u32 s21, s21, 28
    s_lshl_b32 s21, s21, 12
    s_and_b32 s32, s25, 1
    s_lshl_b32 s32, s32, 9
    s_add_u32 s21, s21, s32
    s_add_u32 s21, s21, 0xe00000
    v_mov_b64 v[152:153], -1
    v_mov_b64 v[154:155], -1
    buffer_store_dwordx4 v[152:155], v14, s[16:19], s21 offen offset:0 sc1
    buffer_store_dwordx4 v[152:155], v14, s[16:19], s21 offen offset:2048 sc1
    s_branch L_XFREE
L_TA:
    s_lshl_b32 s29, s7, 12
    s_lshl_b32 s32, s25, 7
    s_add_u32 s29, s29, s32
    s_add_u32 s29, s29, 0x16e0000
    v_mov_b32 v5, s27
    s_mov_b64 exec, 1
    buffer_store_dword v5, v2, s[16:19], s29 offen sc1
    s_mov_b64 exec, -1
    v_cmp_ne_u32 vcc, s27, v10
    s_nop 4
    s_cbranch_vccz L_GOK
    s_mov_b32 s34, 0
PL_5:
    buffer_load_dword v10, v2, s[16:19], s28 offen sc1
    s_waitcnt vmcnt(0)
    v_xor_b32 v10, s27, v10
    v_cmp_ne_u32 vcc, 0, v10
    s_add_u32 s34, s34, 1
    s_cmp_ge_u32 s34, 16384
    s_cbranch_scc1 PL_5_x
    s_cbranch_vccz PL_5_x
    s_sleep 4
    s_branch PL_5
PL_5_x:
L_GOK:
    v_and_b32 v5, 31, v1
    v_lshlrev_b32 v5, 2, v5
    s_lshl_b32 s29, s7, 8
    s_add_u32 s29, s29, 0x1600000
    buffer_load_dword v10, v5, s[16:19], s29 offen sc1
    buffer_load_dword v11, v5, s[16:19], s29 offen offset:128 sc1
    s_branch L_NOG
L_KVWAIT:
    s_mov_b32 s34, 0
LW_6:
    ds_read_b32 v5, v151 offset:36
    s_waitcnt lgkmcnt(0)
    v_readfirstlane_b32 s35, v5
    s_add_u32 s34, s34, 1
    s_cmp_ge_u32 s34, 131072
    s_cbranch_scc1 LW_6_x
    s_cmp_lt_u32 s35, 16843009
    s_cbranch_scc1 LW_6
LW_6_x:
    s_branch L_KVOK
L_REDO:
    s_waitcnt lgkmcnt(0)
    s_mov_b32 s20, 1
    s_mov_b32 s0, 64
    s_mov_b32 s6, 0
    s_mov_b32 s10, 0
    s_mov_b32 s3, 0xff
    s_lshl_b32 s32, s24, 2
    v_mov_b32 v5, s32
    ds_write_b32 v5, v3 offset:96
    s_mov_b32 s34, 0
LW_7:
    s_sleep 8
    ds_read_b32 v5, v2 offset:8
    s_waitcnt lgkmcnt(0)
    v_readfirstlane_b32 s35, v5
    s_add_u32 s34, s34, 1
    s_cmp_ge_u32 s34, 131072
    s_cbranch_scc1 LW_7_x
    s_cmp_lt_u32 s35, 4
    s_cbranch_scc1 LW_7
LW_7_x:
    s_lshl_b32 s30, s25, 16
    s_add_u32 s30, s30, 0x200000
    s_mov_b32 s5, 16
L_RELOAD:
    s_lshr_b32 s32, s5, 3
    s_lshl_b32 s32, s32, 14
    s_and_b32 s35, s5, 7
    s_lshl_b32 s35, s35, 10
    s_add_u32 s32, s32, s35
    s_lshl_b32 s35, s5, 10
    s_add_u32 s35, s35, s30
    s_mov_b32 m0, s32
    s_nop 0
    buffer_load_dwordx4 v4, s[16:19], s35 offen sc1 lds
    s_add_u32 m0, s32, 8192
    s_add_u32 s35, s35, 0x200000
    buffer_load_dwordx4 v4, s[16:19], s35 offen sc1 lds
    s_waitcnt vmcnt(16)
    s_add_u32 s5, s5, 1
    s_cmp_lt_u32 s5, 48
    s_cbranch_scc1 L_RELOAD
    s_waitcnt vmcnt(0)
    s_mov_b64 exec, s[22:23]
    v_mov_b64 v[144:145], 0
    v_mov_b64 v[146:147], 0
    s_mov_b64 exec, -1
    v_mov_b32 v6, 0xff800000
    v_mov_b32 v8, 0xff800000
    v_mov_b64 v[120:121], v[128:129]
    v_mov_b64 v[122:123], v[130:131]
    s_mov_b32 s5, 1
    s_nop 1
L_MAXL:
    v_mfma_f32_32x32x16_bf16 v[16:31], v[120:123], v[112:115], 0
    v_mfma_f32_32x32x16_bf16 v[32:47], v[120:123], v[116:119], 0
    s_lshr_b32 s32, s5, 3
    s_lshl_b32 s32, s32, 14
    s_and_b32 s35, s5, 7
    s_lshl_b32 s35, s35, 10
    s_add_u32 s32, s32, s35
    v_add_u32 v149, s32, v4
    ds_read_b128 v[120:123], v149
    s_nop 15
    v_max3_f32 v6, v6, v16, v17
    v_max3_f32 v6, v6, v18, v19
    v_max3_f32 v6, v6, v20, v21
    v_max3_f32 v6, v6, v22, v23
    v_max3_f32 v6, v6, v24, v25
    v_max3_f32 v6, v6, v26, v27
    v_max3_f32 v6, v6, v28, v29
    v_max3_f32 v6, v6, v30, v31
    v_max3_f32 v8, v8, v32, v33
    v_max3_f32 v8, v8, v34, v35
    v_max3_f32 v8, v8, v36, v37
    v_max3_f32 v8, v8, v38, v39
    v_max3_f32 v8, v8, v40, v41
    v_max3_f32 v8, v8, v42, v43
    v_max3_f32 v8, v8, v44, v45
    v_max3_f32 v8, v8, v46, v47
    s_waitcnt lgkmcnt(0)
    s_add_u32 s5, s5, 1
    s_cmp_lt_u32 s5, 65
    s_cbranch_scc1 L_MAXL
    v_mov_b64 v[48:49], 0
    v_mov_b64 v[50:51], 0
    v_mov_b64 v[52:53], 0
    v_mov_b64 v[54:55], 0
    v_mov_b64 v[56:57], 0
    v_mov_b64 v[58:59], 0
    v_mov_b64 v[60:61], 0
    v_mov_b64 v[62:63], 0
    v_mov_b64 v[64:65], 0
    v_mov_b64 v[66:67], 0
    v_mov_b64 v[68:69], 0
    v_mov_b64 v[70:71], 0
    v_mov_b64 v[72:73], 0
    v_mov_b64 v[74:75], 0
    v_mov_b64 v[76:77], 0
    v_mov_b64 v[78:79], 0
    v_mov_b32 v149, v4
    v_mov_b32 v150, v12
    v_mov_b32 v151, 0
    v_mov_b32 v13, s24
    s_mov_b32 s9, 0x76123450
    s_branch L_SETMAX
L_GSTART:
    s_setprio 2
    s_and_b32 s3, s2, 7
    s_lshr_b32 s4, s2, 3
    s_lshr_b32 s25, s3, 1
    s_lshl_b32 s25, s25, 3
    s_lshr_b32 s6, s4, 2
    s_add_u32 s25, s25, s6
    s_and_b32 s26, s3, 1
    s_lshl_b32 s26, s26, 2
    s_and_b32 s5, s4, 3
    s_add_u32 s26, s26, s5
    s_lshl_b32 s5, s5, 1
    s_add_u32 s6, s6, s5
    s_and_b32 s6, s6, 7
    s_mov_b32 s4, s26
    v_mov_b32 v2, 0
    v_mov_b32 v3, 1
    v_lshlrev_b32 v4, 4, v1
    s_mov_b32 s27, 0
    s_sub_u32 s7, s24, 4
    s_waitcnt lgkmcnt(0)
    s_mov_b32 s8, s44
    s_mov_b32 s9, s45
    s_mov_b32 s10, 0x1c0000
    s_mov_b32 s11, 0x20000
    s_mov_b32 s16, s58
    s_mov_b32 s17, s59
    s_mov_b32 s18, 0x1800000
    s_mov_b32 s19, 0x20000
    s_mov_b32 s60, s56
    s_mov_b32 s61, s57
    s_mov_b32 s62, 0x100
    s_mov_b32 s63, 0x20000
    s_cmp_lg_u32 s7, 3
    s_cbranch_scc1 L_NOLEAD
    v_mov_b64 v[16:17], 0
    v_mov_b64 v[18:19], 0
    ds_write_b128 v4, v[16:19]
    s_cmp_lg_u32 s2, 25
    s_cbranch_scc1 L_NOLEAD
    s_mov_b32 s31, 0x1690000
    buffer_load_dword v16, v2, s[16:19], s31 offen sc1
    s_mov_b32 s32, 0x9e3779b1
    s_waitcnt vmcnt(0)
    v_mul_lo_u32 v16, v16, s32
    v_add_u32 v16, 0x7f4a7c15, v16
    v_max_u32 v16, 1, v16
    s_mov_b64 exec, 1
    buffer_store_dword v16, v2, s[60:63], 0 offen sc1
    buffer_store_dword v16, v2, s[16:19], s31 offen sc1
    s_mov_b64 exec, -1
L_NOLEAD:
    s_lshr_b32 s22, s7, 1
    s_and_b32 s23, s7, 1
    s_lshl_b32 s30, s7, 13
    s_add_u32 s30, s30, 131072
    v_and_b32 v16, 15, v1
    v_lshrrev_b32 v17, 4, v1
    v_bfe_u32 v18, v1, 1, 3
    v_xor_b32 v17, v17, v18
    v_lshlrev_b32 v17, 4, v17
    v_lshl_add_u32 v15, v16, 7, v17
    s_mov_b32 s12, s38
    s_mov_b32 s13, s39
    s_mov_b32 s14, 0x180000
    s_mov_b32 s15, 0x20000
    v_lshrrev_b32 v16, 3, v1
    s_lshl_b32 s29, s7, 4
    v_add_u32 v16, s29, v16
    v_mul_u32_u24 v16, 3072, v16
    v_bfe_u32 v17, v1, 4, 1
    v_lshlrev_b32 v17, 1, v17
    v_and_b32 v18, 7, v1
    v_xor_b32 v17, v17, v18
    v_lshlrev_b32 v17, 4, v17
    s_lshl_b32 s28, s26, 7
    v_add3_u32 v180, v16, v17, s28
    v_xor_b32 v181, 64, v180
    v_add_u32 v181, 23552, v181
    s_lshl_b32 s1, s7, 11
    s_add_u32 s1, s1, 81920
    s_add_u32 s0, s6, 2
    s_and_b32 s0, s0, 7
    s_cmp_lt_u32 s4, 7
    s_cbranch_scc1 L_Z2S
    s_waitcnt lgkmcnt(0)
    s_lshl_b32 s28, s25, 2
    s_add_u32 s28, s28, s7
    s_barrier
    s_mul_i32 s32, s28, 12288
    v_lshlrev_b32 v16, 7, v1
    v_min_u32 v17, 31, v1
    v_lshlrev_b32 v17, 7, v17
    v_add_u32 v17, 0x2000, v17
    buffer_load_dword v29, v16, s[12:15], s32 offen
    buffer_load_dword v29, v17, s[12:15], s32 offen
    s_barrier
    s_barrier
    s_barrier
    s_barrier
    s_barrier
    s_barrier
    s_mul_i32 s32, s28, 14336
    v_lshrrev_b32 v16, 4, v1
    v_mul_u32_u24 v16, 3584, v16
    v_and_b32 v17, 15, v1
    v_min_u32 v17, 13, v17
    v_lshl_add_u32 v16, v17, 7, v16
    buffer_load_dword v29, v16, s[8:11], s32 offen
    s_barrier
    s_mov_b32 s10, 0
    s_branch L_ZEND
L_Z2S:
    s_lshl_b32 s32, s22, 13
    s_add_u32 s32, s32, 106496
    v_lshrrev_b32 v16, 4, v1
    v_bfe_u32 v17, v1, 2, 2
    v_lshl_add_u32 v16, v16, 3, v17
    v_lshlrev_b32 v16, 7, v16
    v_bfe_u32 v17, v1, 3, 2
    v_lshl_add_u32 v16, v17, 5, v16
    v_and_b32 v17, 3, v1
    v_lshl_add_u32 v16, v17, 3, v16
    v_add_u32 v9, s32, v16
    v_xor_b32 v10, 32, v9
    v_xor_b32 v11, 64, v9
    v_xor_b32 v12, 96, v9
    v_mov_b32 v5, v9
    s_lshl_b32 s20, s23, 12
    s_add_u32 s20, s20, 16384
    v_mov_b64 v[192:193], 0
    v_mov_b64 v[194:195], 0
    v_mov_b64 v[196:197], 0
    v_mov_b64 v[198:199], 0
    v_mov_b64 v[200:201], 0
    v_mov_b64 v[202:203], 0
    v_mov_b64 v[204:205], 0
    v_mov_b64 v[206:207], 0
    v_mov_b64 v[208:209], 0
    v_mov_b64 v[210:211], 0
    v_mov_b64 v[212:213], 0
    v_mov_b64 v[214:215], 0
    v_mov_b64 v[216:217], 0
    v_mov_b64 v[218:219], 0
    v_mov_b64 v[220:221], 0
    v_mov_b64 v[222:223], 0
    v_mov_b64 v[64:65], 0
    v_mov_b64 v[66:67], 0
    v_mov_b64 v[68:69], 0
    v_mov_b64 v[70:71], 0
    v_mov_b64 v[72:73], 0
    v_mov_b64 v[74:75], 0
    v_mov_b64 v[76:77], 0
    v_mov_b64 v[78:79], 0
    v_mov_b64 v[80:81], 0
    v_mov_b64 v[82:83], 0
    v_mov_b64 v[84:85], 0
    v_mov_b64 v[86:87], 0
    v_mov_b64 v[88:89], 0
    v_mov_b64 v[90:91], 0
    v_mov_b64 v[92:93], 0
    v_mov_b64 v[94:95], 0
    v_mov_b64 v[96:97], 0
    v_mov_b64 v[98:99], 0
    v_mov_b64 v[100:101], 0
    v_mov_b64 v[102:103], 0
    v_mov_b64 v[104:105], 0
    v_mov_b64 v[106:107], 0
    v_mov_b64 v[108:109], 0
    v_mov_b64 v[110:111], 0
    s_mov_b32 s33, 16384
    s_mov_b32 s5, 0
    s_mov_b32 s21, s6
    s_waitcnt lgkmcnt(0)
L_ZLOOP:
    s_lshl_b32 s32, s21, 13
    s_add_u32 s32, s32, s20
    v_add_u32 v13, s32, v15
    v_xor_b32 v14, 64, v13
    v_add_u32 v9, s33, v5
    v_xor_b32 v10, 32, v9
    v_xor_b32 v11, 64, v9
    v_xor_b32 v12, 96, v9
    s_add_u32 s21, s21, 1
    s_and_b32 s21, s21, 7
    s_add_u32 s33, s33, 16384
    s_cmp_eq_u32 s33, 49152
    s_cselect_b32 s33, 0, s33
    s_barrier
.p2align 3
    ds_read_b128 v[16:19], v13 offset:0
    ds_read_b128 v[20:23], v14 offset:0
    v_mfma_f32_16x16x32_bf16 v[192:195], v[80:83], v[64:67], v[192:195]
    ds_read_b128 v[24:27], v13 offset:2048
    ds_read_b128 v[28:31], v14 offset:2048
    v_mfma_f32_16x16x32_bf16 v[192:195], v[84:87], v[68:71], v[192:195]
    ds_read_b64_tr_b16 v[32:33], v9 offset:0
    ds_read_b64_tr_b16 v[34:35], v9 offset:512
    v_mfma_f32_16x16x32_bf16 v[196:199], v[80:83], v[72:75], v[196:199]
    ds_read_b64_tr_b16 v[36:37], v9 offset:4096
    ds_read_b64_tr_b16 v[38:39], v9 offset:4608
    v_mfma_f32_16x16x32_bf16 v[196:199], v[84:87], v[76:79], v[196:199]
    ds_read_b64_tr_b16 v[40:41], v10 offset:0
    ds_read_b64_tr_b16 v[42:43], v10 offset:512
    v_mfma_f32_16x16x32_bf16 v[200:203], v[88:91], v[64:67], v[200:203]
    ds_read_b64_tr_b16 v[44:45], v10 offset:4096
    ds_read_b64_tr_b16 v[46:47], v10 offset:4608
    v_mfma_f32_16x16x32_bf16 v[200:203], v[92:95], v[68:71], v[200:203]
    ds_read_b64_tr_b16 v[48:49], v11 offset:0
    ds_read_b64_tr_b16 v[50:51], v11 offset:512
    v_mfma_f32_16x16x32_bf16 v[204:207], v[88:91], v[72:75], v[204:207]
    s_waitcnt lgkmcnt(8)
    s_nop 0
    ds_read_b64_tr_b16 v[52:53], v11 offset:4096
    ds_read_b64_tr_b16 v[54:55], v11 offset:4608
    v_mfma_f32_16x16x32_bf16 v[204:207], v[92:95], v[76:79], v[204:207]
    ds_read_b64_tr_b16 v[56:57], v12 offset:0
    ds_read_b64_tr_b16 v[58:59], v12 offset:512
    v_mfma_f32_16x16x32_bf16 v[208:211], v[96:99], v[64:67], v[208:211]
    ds_read_b64_tr_b16 v[60:61], v12 offset:4096
    ds_read_b64_tr_b16 v[62:63], v12 offset:4608
    v_mfma_f32_16x16x32_bf16 v[208:211], v[100:103], v[68:71], v[208:211]
    v_mfma_f32_16x16x32_bf16 v[212:215], v[96:99], v[72:75], v[212:215]
    v_mfma_f32_16x16x32_bf16 v[212:215], v[100:103], v[76:79], v[212:215]
    v_mfma_f32_16x16x32_bf16 v[216:219], v[104:107], v[64:67], v[216:219]
    v_mfma_f32_16x16x32_bf16 v[216:219], v[108:111], v[68:71], v[216:219]
    v_mfma_f32_16x16x32_bf16 v[220:223], v[104:107], v[72:75], v[220:223]
    v_mfma_f32_16x16x32_bf16 v[220:223], v[108:111], v[76:79], v[220:223]
    s_waitcnt lgkmcnt(0)
    s_lshl_b32 s32, s21, 13
    s_add_u32 s32, s32, s20
    v_add_u32 v13, s32, v15
    v_xor_b32 v14, 64, v13
    v_add_u32 v9, s33, v5
    v_xor_b32 v10, 32, v9
    v_xor_b32 v11, 64, v9
    v_xor_b32 v12, 96, v9
    s_add_u32 s21, s21, 1
    s_and_b32 s21, s21, 7
    s_add_u32 s33, s33, 16384
    s_cmp_eq_u32 s33, 49152
    s_cselect_b32 s33, 0, s33
    s_barrier
.p2align 3
    ds_read_b128 v[64:67], v13 offset:0
    ds_read_b128 v[68:71], v14 offset:0
    v_mfma_f32_16x16x32_bf16 v[192:195], v[32:35], v[16:19], v[192:195]
    ds_read_b128 v[72:75], v13 offset:2048
    ds_read_b128 v[76:79], v14 offset:2048
    v_mfma_f32_16x16x32_bf16 v[192:195], v[36:39], v[20:23], v[192:195]
    ds_read_b64_tr_b16 v[80:81], v9 offset:0
    ds_read_b64_tr_b16 v[82:83], v9 offset:512
    v_mfma_f32_16x16x32_bf16 v[196:199], v[32:35], v[24:27], v[196:199]
    ds_read_b64_tr_b16 v[84:85], v9 offset:4096
    ds_read_b64_tr_b16 v[86:87], v9 offset:4608
    v_mfma_f32_16x16x32_bf16 v[196:199], v[36:39], v[28:31], v[196:199]
    ds_read_b64_tr_b16 v[88:89], v10 offset:0
    ds_read_b64_tr_b16 v[90:91], v10 offset:512
    v_mfma_f32_16x16x32_bf16 v[200:203], v[40:43], v[16:19], v[200:203]
    ds_read_b64_tr_b16 v[92:93], v10 offset:4096
    ds_read_b64_tr_b16 v[94:95], v10 offset:4608
    v_mfma_f32_16x16x32_bf16 v[200:203], v[44:47], v[20:23], v[200:203]
    ds_read_b64_tr_b16 v[96:97], v11 offset:0
    ds_read_b64_tr_b16 v[98:99], v11 offset:512
    v_mfma_f32_16x16x32_bf16 v[204:207], v[40:43], v[24:27], v[204:207]
    s_waitcnt lgkmcnt(8)
    s_nop 0
    ds_read_b64_tr_b16 v[100:101], v11 offset:4096
    ds_read_b64_tr_b16 v[102:103], v11 offset:4608
    v_mfma_f32_16x16x32_bf16 v[204:207], v[44:47], v[28:31], v[204:207]
    ds_read_b64_tr_b16 v[104:105], v12 offset:0
    ds_read_b64_tr_b16 v[106:107], v12 offset:512
    v_mfma_f32_16x16x32_bf16 v[208:211], v[48:51], v[16:19], v[208:211]
    ds_read_b64_tr_b16 v[108:109], v12 offset:4096
    ds_read_b64_tr_b16 v[110:111], v12 offset:4608
    v_mfma_f32_16x16x32_bf16 v[208:211], v[52:55], v[20:23], v[208:211]
    v_mfma_f32_16x16x32_bf16 v[212:215], v[48:51], v[24:27], v[212:215]
    v_mfma_f32_16x16x32_bf16 v[212:215], v[52:55], v[28:31], v[212:215]
    v_mfma_f32_16x16x32_bf16 v[216:219], v[56:59], v[16:19], v[216:219]
    v_mfma_f32_16x16x32_bf16 v[216:219], v[60:63], v[20:23], v[216:219]
    v_mfma_f32_16x16x32_bf16 v[220:223], v[56:59], v[24:27], v[220:223]
    v_mfma_f32_16x16x32_bf16 v[220:223], v[60:63], v[28:31], v[220:223]
    s_waitcnt lgkmcnt(0)
    s_add_u32 s5, s5, 1
    s_cmp_lt_u32 s5, 4
    s_cbranch_scc1 L_ZLOOP
L_ZEND:
    s_barrier
    s_mul_i32 s31, s0, 196608
    s_add_u32 m0, s1, 49152
    s_add_u32 s0, s0, 1
    buffer_load_dwordx4 v180, s[12:15], s31 offen offset:0 lds
    buffer_load_dwordx4 v181, s[12:15], s31 offen offset:1024 lds
    s_add_u32 m0, s1, 56320
    s_and_b32 s0, s0, 7
    buffer_load_dwordx4 v180, s[12:15], s31 offen offset:1024 lds
    buffer_load_dwordx4 v181, s[12:15], s31 offen offset:2048 lds
    s_add_u32 m0, s1, 63488
    s_nop 0
    buffer_load_dwordx4 v180, s[12:15], s31 offen offset:2048 lds
    buffer_load_dwordx4 v181, s[12:15], s31 offen offset:3072 lds
    v_mfma_f32_16x16x32_bf16 v[192:195], v[80:83], v[64:67], v[192:195]
    v_mfma_f32_16x16x32_bf16 v[192:195], v[84:87], v[68:71], v[192:195]
    v_mfma_f32_16x16x32_bf16 v[196:199], v[80:83], v[72:75], v[196:199]
    v_mfma_f32_16x16x32_bf16 v[196:199], v[84:87], v[76:79], v[196:199]
    v_mfma_f32_16x16x32_bf16 v[200:203], v[88:91], v[64:67], v[200:203]
    v_mfma_f32_16x16x32_bf16 v[200:203], v[92:95], v[68:71], v[200:203]
    v_mfma_f32_16x16x32_bf16 v[204:207], v[88:91], v[72:75], v[204:207]
    v_mfma_f32_16x16x32_bf16 v[204:207], v[92:95], v[76:79], v[204:207]
    v_mfma_f32_16x16x32_bf16 v[208:211], v[96:99], v[64:67], v[208:211]
    v_mfma_f32_16x16x32_bf16 v[208:211], v[100:103], v[68:71], v[208:211]
    v_mfma_f32_16x16x32_bf16 v[212:215], v[96:99], v[72:75], v[212:215]
    v_mfma_f32_16x16x32_bf16 v[212:215], v[100:103], v[76:79], v[212:215]
    v_mfma_f32_16x16x32_bf16 v[216:219], v[104:107], v[64:67], v[216:219]
    v_mfma_f32_16x16x32_bf16 v[216:219], v[108:111], v[68:71], v[216:219]
    v_mfma_f32_16x16x32_bf16 v[220:223], v[104:107], v[72:75], v[220:223]
    v_mfma_f32_16x16x32_bf16 v[220:223], v[108:111], v[76:79], v[220:223]
    s_barrier
    s_mul_i32 s31, s0, 196608
    s_add_u32 m0, s1, 0
    s_add_u32 s0, s0, 1
    buffer_load_dwordx4 v180, s[12:15], s31 offen offset:0 lds
    buffer_load_dwordx4 v181, s[12:15], s31 offen offset:1024 lds
    s_add_u32 m0, s1, 7168
    s_and_b32 s0, s0, 7
    buffer_load_dwordx4 v180, s[12:15], s31 offen offset:1024 lds
    buffer_load_dwordx4 v181, s[12:15], s31 offen offset:2048 lds
    s_add_u32 m0, s1, 14336
    s_nop 0
    buffer_load_dwordx4 v180, s[12:15], s31 offen offset:2048 lds
    buffer_load_dwordx4 v181, s[12:15], s31 offen offset:3072 lds
    s_mov_b32 s20, 0xbdd2d3e8
    s_mov_b32 s21, 0xbdd2d3e8
    v_mov_b32 v24, 0xc0135761
    v_mov_b32 v25, 0xc0135761
    v_mov_b32 v26, 1.0
    v_mov_b32 v27, 1.0
    s_mov_b32 s28, 3584
    s_lshl_b32 s29, s4, 8
    s_lshl_b32 s32, s22, 7
    s_add_u32 s29, s29, s32
    v_lshrrev_b32 v16, 3, v1
    v_mul_lo_u32 v16, v16, s28
    v_bfe_u32 v17, v1, 4, 1
    v_lshlrev_b32 v17, 1, v17
    v_and_b32 v18, 7, v1
    v_xor_b32 v17, v17, v18
    v_lshl_add_u32 v16, v17, 4, v16
    v_add_u32 v5, s29, v16
    s_lshl_b32 s32, s28, 3
    s_sub_u32 s32, s32, 1024
    v_xor_b32 v6, 64, v5
    v_add_u32 v6, s32, v6
    s_lshl_b32 s32, s32, 1
    v_add_u32 v7, s32, v5
    v_add_u32 v8, s32, v6
    s_waitcnt vmcnt(6)
    s_barrier
    s_mul_i32 s31, s0, 196608
    s_add_u32 m0, s1, 24576
    s_add_u32 s0, s0, 1
    buffer_load_dwordx4 v180, s[12:15], s31 offen offset:0 lds
    buffer_load_dwordx4 v181, s[12:15], s31 offen offset:1024 lds
    s_add_u32 m0, s1, 31744
    s_and_b32 s0, s0, 7
    buffer_load_dwordx4 v180, s[12:15], s31 offen offset:1024 lds
    buffer_load_dwordx4 v181, s[12:15], s31 offen offset:2048 lds
    s_add_u32 m0, s1, 38912
    s_nop 0
    buffer_load_dwordx4 v180, s[12:15], s31 offen offset:2048 lds
    buffer_load_dwordx4 v181, s[12:15], s31 offen offset:3072 lds
    s_sub_u32 s32, s30, 32768
    v_lshrrev_b32 v20, 4, v1
    v_bfe_u32 v21, v1, 2, 2
    v_lshl_add_u32 v20, v20, 3, v21
    v_lshlrev_b32 v20, 7, v20
    v_bfe_u32 v21, v1, 3, 2
    v_lshl_add_u32 v20, v21, 5, v20
    v_and_b32 v21, 3, v1
    v_lshl_add_u32 v20, v21, 3, v20
    v_add_u32 v9, s32, v20
    v_xor_b32 v10, 32, v9
    v_xor_b32 v11, 64, v9
    v_xor_b32 v12, 96, v9
    s_lshl_b32 s32, s23, 6
    v_xor_b32 v9, s32, v9
    v_xor_b32 v10, s32, v10
    v_xor_b32 v11, s32, v11
    v_xor_b32 v12, s32, v12
    s_waitcnt vmcnt(6)
    s_barrier
    s_mul_i32 s31, s0, 196608
    s_add_u32 m0, s1, 49152
    s_add_u32 s0, s0, 1
    buffer_load_dwordx4 v180, s[12:15], s31 offen offset:0 lds
    buffer_load_dwordx4 v181, s[12:15], s31 offen offset:1024 lds
    s_add_u32 m0, s1, 56320
    s_and_b32 s0, s0, 7
    buffer_load_dwordx4 v180, s[12:15], s31 offen offset:1024 lds
    buffer_load_dwordx4 v181, s[12:15], s31 offen offset:2048 lds
    s_add_u32 m0, s1, 63488
    s_nop 0
    buffer_load_dwordx4 v180, s[12:15], s31 offen offset:2048 lds
    buffer_load_dwordx4 v181, s[12:15], s31 offen offset:3072 lds
    s_waitcnt vmcnt(6)
    s_barrier
    s_mul_i32 s31, s0, 196608
    s_add_u32 m0, s1, 0
    s_add_u32 s0, s0, 1
    buffer_load_dwordx4 v180, s[12:15], s31 offen offset:0 lds
    buffer_load_dwordx4 v181, s[12:15], s31 offen offset:1024 lds
    s_add_u32 m0, s1, 7168
    s_and_b32 s0, s0, 7
    buffer_load_dwordx4 v180, s[12:15], s31 offen offset:1024 lds
    buffer_load_dwordx4 v181, s[12:15], s31 offen offset:2048 lds
    s_add_u32 m0, s1, 14336
    s_nop 0
    buffer_load_dwordx4 v180, s[12:15], s31 offen offset:2048 lds
    buffer_load_dwordx4 v181, s[12:15], s31 offen offset:3072 lds
    s_waitcnt vmcnt(6)
    s_barrier
    s_mul_i32 s31, s0, 196608
    s_add_u32 m0, s1, 24576
    s_add_u32 s0, s0, 1
    buffer_load_dwordx4 v180, s[12:15], s31 offen offset:0 lds
    buffer_load_dwordx4 v181, s[12:15], s31 offen offset:1024 lds
    s_add_u32 m0, s1, 31744
    s_and_b32 s0, s0, 7
    buffer_load_dwordx4 v180, s[12:15], s31 offen offset:1024 lds
    buffer_load_dwordx4 v181, s[12:15], s31 offen offset:2048 lds
    s_add_u32 m0, s1, 38912
    s_nop 0
    buffer_load_dwordx4 v180, s[12:15], s31 offen offset:2048 lds
    buffer_load_dwordx4 v181, s[12:15], s31 offen offset:3072 lds
    s_waitcnt vmcnt(6)
    s_barrier
    s_lshl_b32 s29, s28, 5
    s_lshl_b32 s3, s23, 3
    s_mul_i32 s3, s3, s29
    s_lshl_b32 s33, s29, 3
    s_add_u32 s33, s33, s3
    s_and_b32 s6, s25, 3
    s_lshl_b32 s32, s6, 1
    s_mul_i32 s31, s32, s29
    s_add_u32 s31, s31, s3
    s_lshl_b32 s5, s23, 15
    s_add_u32 s5, s5, 16384
    buffer_load_dword v28, v2, s[60:63], 0 offen sc1
    s_add_u32 m0, s30, 0
    s_nop 0
    buffer_load_dwordx4 v5, s[8:11], s31 offen offset:0 lds
    buffer_load_dwordx4 v6, s[8:11], s31 offen offset:1024 lds
    buffer_load_dwordx4 v7, s[8:11], s31 offen offset:2048 lds
    buffer_load_dwordx4 v8, s[8:11], s31 offen offset:3072 lds
    s_add_u32 s31, s31, s29
    s_cmp_ge_u32 s31, s33
    s_cselect_b32 s31, s3, s31
    s_add_u32 m0, s30, 4096
    s_nop 0
    buffer_load_dwordx4 v5, s[8:11], s31 offen offset:0 lds
    buffer_load_dwordx4 v6, s[8:11], s31 offen offset:1024 lds
    buffer_load_dwordx4 v7, s[8:11], s31 offen offset:2048 lds
    buffer_load_dwordx4 v8, s[8:11], s31 offen offset:3072 lds
    s_add_u32 s31, s31, s29
    s_cmp_ge_u32 s31, s33
    s_cselect_b32 s31, s3, s31
    s_lshl_b32 s32, s6, 13
    s_add_u32 s32, s32, s5
    v_add_u32 v13, s32, v15
    v_xor_b32 v14, 64, v13
    s_add_u32 s6, s6, 1
    s_and_b32 s6, s6, 3
    s_waitcnt vmcnt(9)
    s_barrier
    s_barrier
    s_cmp_ge_u32 s4, 7
    s_cbranch_scc1 L_G7
    s_add_u32 m0, s30, -32768
    s_nop 0
    buffer_load_dwordx4 v5, s[8:11], s31 offen offset:0 lds
    buffer_load_dwordx4 v6, s[8:11], s31 offen offset:1024 lds
    buffer_load_dwordx4 v7, s[8:11], s31 offen offset:2048 lds
    buffer_load_dwordx4 v8, s[8:11], s31 offen offset:3072 lds
    s_add_u32 s31, s31, s29
    s_cmp_ge_u32 s31, s33
    s_cselect_b32 s31, s3, s31
    s_add_u32 m0, s30, -28672
    s_nop 0
    buffer_load_dwordx4 v5, s[8:11], s31 offen offset:0 lds
    buffer_load_dwordx4 v6, s[8:11], s31 offen offset:1024 lds
    buffer_load_dwordx4 v7, s[8:11], s31 offen offset:2048 lds
    buffer_load_dwordx4 v8, s[8:11], s31 offen offset:3072 lds
    s_add_u32 s31, s31, s29
    s_cmp_ge_u32 s31, s33
    s_cselect_b32 s31, s3, s31
    s_waitcnt vmcnt(8)
    ds_read_b64_tr_b16 v[96:97], v9 offset:32768
    ds_read_b64_tr_b16 v[98:99], v9 offset:33280
    ds_read_b64_tr_b16 v[100:101], v9 offset:36864
    ds_read_b64_tr_b16 v[102:103], v9 offset:37376
    ds_read_b64_tr_b16 v[104:105], v10 offset:32768
    ds_read_b64_tr_b16 v[106:107], v10 offset:33280
    ds_read_b64_tr_b16 v[108:109], v10 offset:36864
    ds_read_b64_tr_b16 v[110:111], v10 offset:37376
    ds_read_b64_tr_b16 v[112:113], v11 offset:32768
    ds_read_b64_tr_b16 v[114:115], v11 offset:33280
    ds_read_b64_tr_b16 v[116:117], v11 offset:36864
    ds_read_b64_tr_b16 v[118:119], v11 offset:37376
    s_waitcnt lgkmcnt(3)
    s_nop 0
    ds_read_b64_tr_b16 v[120:121], v12 offset:32768
    ds_read_b64_tr_b16 v[122:123], v12 offset:33280
    ds_read_b64_tr_b16 v[124:125], v12 offset:36864
    ds_read_b64_tr_b16 v[126:127], v12 offset:37376
    ds_read_b128 v[64:67], v13 offset:0
    ds_read_b128 v[68:71], v14 offset:0
    ds_read_b128 v[72:75], v13 offset:2048
    ds_read_b128 v[76:79], v14 offset:2048
    ds_read_b128 v[80:83], v13 offset:4096
    ds_read_b128 v[84:87], v14 offset:4096
    ds_read_b128 v[88:91], v13 offset:6144
    ds_read_b128 v[92:95], v14 offset:6144
    v_pk_mul_f32 v[16:17], v[192:193], v[192:193]
    v_pk_mul_f32 v[18:19], v[194:195], v[194:195]
    v_pk_mul_f32 v[20:21], v[196:197], v[196:197]
    v_pk_mul_f32 v[22:23], v[198:199], v[198:199]
    v_pk_fma_f32 v[16:17], v[16:17], s[20:21], v[24:25]
    v_pk_fma_f32 v[18:19], v[18:19], s[20:21], v[24:25]
    v_pk_fma_f32 v[20:21], v[20:21], s[20:21], v[24:25]
    v_pk_fma_f32 v[22:23], v[22:23], s[20:21], v[24:25]
    v_pk_mul_f32 v[16:17], v[16:17], v[192:193]
    v_pk_mul_f32 v[18:19], v[18:19], v[194:195]
    v_pk_mul_f32 v[20:21], v[20:21], v[196:197]
    v_pk_mul_f32 v[22:23], v[22:23], v[198:199]
    v_exp_f32 v16, v16
    v_exp_f32 v17, v17
    v_exp_f32 v18, v18
    v_exp_f32 v19, v19
    v_exp_f32 v20, v20
    v_exp_f32 v21, v21
    v_exp_f32 v22, v22
    v_exp_f32 v23, v23
    v_pk_add_f32 v[16:17], v[16:17], v[26:27]
    v_pk_add_f32 v[18:19], v[18:19], v[26:27]
    v_pk_add_f32 v[20:21], v[20:21], v[26:27]
    v_pk_add_f32 v[22:23], v[22:23], v[26:27]
    v_rcp_f32 v16, v16
    v_rcp_f32 v17, v17
    v_rcp_f32 v18, v18
    v_rcp_f32 v19, v19
    v_rcp_f32 v20, v20
    v_rcp_f32 v21, v21
    v_rcp_f32 v22, v22
    v_rcp_f32 v23, v23
    v_pk_mul_f32 v[192:193], v[192:193], v[16:17]
    v_pk_mul_f32 v[194:195], v[194:195], v[18:19]
    v_pk_mul_f32 v[196:197], v[196:197], v[20:21]
    v_pk_mul_f32 v[198:199], v[198:199], v[22:23]
    v_pk_mul_f32 v[16:17], v[200:201], v[200:201]
    v_pk_mul_f32 v[18:19], v[202:203], v[202:203]
    v_pk_mul_f32 v[20:21], v[204:205], v[204:205]
    v_pk_mul_f32 v[22:23], v[206:207], v[206:207]
    v_pk_fma_f32 v[16:17], v[16:17], s[20:21], v[24:25]
    v_pk_fma_f32 v[18:19], v[18:19], s[20:21], v[24:25]
    v_pk_fma_f32 v[20:21], v[20:21], s[20:21], v[24:25]
    v_pk_fma_f32 v[22:23], v[22:23], s[20:21], v[24:25]
    v_pk_mul_f32 v[16:17], v[16:17], v[200:201]
    v_pk_mul_f32 v[18:19], v[18:19], v[202:203]
    v_pk_mul_f32 v[20:21], v[20:21], v[204:205]
    v_pk_mul_f32 v[22:23], v[22:23], v[206:207]
    v_exp_f32 v16, v16
    v_exp_f32 v17, v17
    v_exp_f32 v18, v18
    v_exp_f32 v19, v19
    v_exp_f32 v20, v20
    v_exp_f32 v21, v21
    v_exp_f32 v22, v22
    v_exp_f32 v23, v23
    v_pk_add_f32 v[16:17], v[16:17], v[26:27]
    v_pk_add_f32 v[18:19], v[18:19], v[26:27]
    v_pk_add_f32 v[20:21], v[20:21], v[26:27]
    v_pk_add_f32 v[22:23], v[22:23], v[26:27]
    v_rcp_f32 v16, v16
    v_rcp_f32 v17, v17
    v_rcp_f32 v18, v18
    v_rcp_f32 v19, v19
    v_rcp_f32 v20, v20
    v_rcp_f32 v21, v21
    v_rcp_f32 v22, v22
    v_rcp_f32 v23, v23
    v_pk_mul_f32 v[200:201], v[200:201], v[16:17]
    v_pk_mul_f32 v[202:203], v[202:203], v[18:19]
    v_pk_mul_f32 v[204:205], v[204:205], v[20:21]
    v_pk_mul_f32 v[206:207], v[206:207], v[22:23]
    v_pk_mul_f32 v[16:17], v[208:209], v[208:209]
    v_pk_mul_f32 v[18:19], v[210:211], v[210:211]
    v_pk_mul_f32 v[20:21], v[212:213], v[212:213]
    v_pk_mul_f32 v[22:23], v[214:215], v[214:215]
    v_pk_fma_f32 v[16:17], v[16:17], s[20:21], v[24:25]
    v_pk_fma_f32 v[18:19], v[18:19], s[20:21], v[24:25]
    v_pk_fma_f32 v[20:21], v[20:21], s[20:21], v[24:25]
    v_pk_fma_f32 v[22:23], v[22:23], s[20:21], v[24:25]
    v_pk_mul_f32 v[16:17], v[16:17], v[208:209]
    v_pk_mul_f32 v[18:19], v[18:19], v[210:211]
    v_pk_mul_f32 v[20:21], v[20:21], v[212:213]
    v_pk_mul_f32 v[22:23], v[22:23], v[214:215]
    v_exp_f32 v16, v16
    v_exp_f32 v17, v17
    v_exp_f32 v18, v18
    v_exp_f32 v19, v19
    v_exp_f32 v20, v20
    v_exp_f32 v21, v21
    v_exp_f32 v22, v22
    v_exp_f32 v23, v23
    v_pk_add_f32 v[16:17], v[16:17], v[26:27]
    v_pk_add_f32 v[18:19], v[18:19], v[26:27]
    v_pk_add_f32 v[20:21], v[20:21], v[26:27]
    v_pk_add_f32 v[22:23], v[22:23], v[26:27]
    v_rcp_f32 v16, v16
    v_rcp_f32 v17, v17
    v_rcp_f32 v18, v18
    v_rcp_f32 v19, v19
    v_rcp_f32 v20, v20
    v_rcp_f32 v21, v21
    v_rcp_f32 v22, v22
    v_rcp_f32 v23, v23
    v_pk_mul_f32 v[208:209], v[208:209], v[16:17]
    v_pk_mul_f32 v[210:211], v[210:211], v[18:19]
    v_pk_mul_f32 v[212:213], v[212:213], v[20:21]
    v_pk_mul_f32 v[214:215], v[214:215], v[22:23]
    v_pk_mul_f32 v[16:17], v[216:217], v[216:217]
    v_pk_mul_f32 v[18:19], v[218:219], v[218:219]
    v_pk_mul_f32 v[20:21], v[220:221], v[220:221]
    v_pk_mul_f32 v[22:23], v[222:223], v[222:223]
    v_pk_fma_f32 v[16:17], v[16:17], s[20:21], v[24:25]
    v_pk_fma_f32 v[18:19], v[18:19], s[20:21], v[24:25]
    v_pk_fma_f32 v[20:21], v[20:21], s[20:21], v[24:25]
    v_pk_fma_f32 v[22:23], v[22:23], s[20:21], v[24:25]
    v_pk_mul_f32 v[16:17], v[16:17], v[216:217]
    v_pk_mul_f32 v[18:19], v[18:19], v[218:219]
    v_pk_mul_f32 v[20:21], v[20:21], v[220:221]
    v_pk_mul_f32 v[22:23], v[22:23], v[222:223]
    v_exp_f32 v16, v16
    v_exp_f32 v17, v17
    v_exp_f32 v18, v18
    v_exp_f32 v19, v19
    v_exp_f32 v20, v20
    v_exp_f32 v21, v21
    v_exp_f32 v22, v22
    v_exp_f32 v23, v23
    v_pk_add_f32 v[16:17], v[16:17], v[26:27]
    v_pk_add_f32 v[18:19], v[18:19], v[26:27]
    v_pk_add_f32 v[20:21], v[20:21], v[26:27]
    v_pk_add_f32 v[22:23], v[22:23], v[26:27]
    v_rcp_f32 v16, v16
    v_rcp_f32 v17, v17
    v_rcp_f32 v18, v18
    v_rcp_f32 v19, v19
    v_rcp_f32 v20, v20
    v_rcp_f32 v21, v21
    v_rcp_f32 v22, v22
    v_rcp_f32 v23, v23
    v_pk_mul_f32 v[216:217], v[216:217], v[16:17]
    v_pk_mul_f32 v[218:219], v[218:219], v[18:19]
    v_pk_mul_f32 v[220:221], v[220:221], v[20:21]
    v_pk_mul_f32 v[222:223], v[222:223], v[22:23]
    v_pk_mul_f32 v[20:21], v[192:193], v[192:193]
    v_pk_add_f32 v[16:17], v[192:193], v[194:195]
    v_pk_fma_f32 v[20:21], v[194:195], v[194:195], v[20:21]
    v_pk_fma_f32 v[20:21], v[200:201], v[200:201], v[20:21]
    v_pk_add_f32 v[16:17], v[16:17], v[200:201]
    v_pk_fma_f32 v[20:21], v[202:203], v[202:203], v[20:21]
    v_pk_add_f32 v[16:17], v[16:17], v[202:203]
    v_pk_fma_f32 v[20:21], v[208:209], v[208:209], v[20:21]
    v_pk_add_f32 v[16:17], v[16:17], v[208:209]
    v_pk_fma_f32 v[20:21], v[210:211], v[210:211], v[20:21]
    v_pk_add_f32 v[16:17], v[16:17], v[210:211]
    v_pk_fma_f32 v[20:21], v[216:217], v[216:217], v[20:21]
    v_pk_add_f32 v[16:17], v[16:17], v[216:217]
    v_pk_fma_f32 v[20:21], v[218:219], v[218:219], v[20:21]
    v_pk_add_f32 v[16:17], v[16:17], v[218:219]
    v_pk_mul_f32 v[22:23], v[196:197], v[196:197]
    v_pk_add_f32 v[18:19], v[196:197], v[198:199]
    v_pk_fma_f32 v[22:23], v[198:199], v[198:199], v[22:23]
    v_pk_fma_f32 v[22:23], v[204:205], v[204:205], v[22:23]
    v_pk_add_f32 v[18:19], v[18:19], v[204:205]
    v_pk_fma_f32 v[22:23], v[206:207], v[206:207], v[22:23]
    v_pk_add_f32 v[18:19], v[18:19], v[206:207]
    v_pk_fma_f32 v[22:23], v[212:213], v[212:213], v[22:23]
    v_pk_add_f32 v[18:19], v[18:19], v[212:213]
    v_pk_fma_f32 v[22:23], v[214:215], v[214:215], v[22:23]
    v_pk_add_f32 v[18:19], v[18:19], v[214:215]
    v_pk_fma_f32 v[22:23], v[220:221], v[220:221], v[22:23]
    v_pk_add_f32 v[18:19], v[18:19], v[220:221]
    v_pk_fma_f32 v[22:23], v[222:223], v[222:223], v[22:23]
    v_pk_add_f32 v[18:19], v[18:19], v[222:223]
    v_add_f32 v16, v16, v17
    v_add_f32 v18, v18, v19
    v_add_f32 v20, v20, v21
    v_add_f32 v22, v22, v23
    s_nop 1
    v_permlane16_swap_b32 v16, v18
    v_permlane16_swap_b32 v20, v22
    s_nop 1
    v_add_f32 v16, v16, v18
    v_add_f32 v18, v20, v22
    v_mov_b32 v17, v16
    v_mov_b32 v19, v18
    s_nop 1
    v_permlane32_swap_b32 v16, v17
    v_permlane32_swap_b32 v18, v19
    s_nop 1
    v_add_f32 v16, v16, v17
    v_add_f32 v18, v18, v19
    s_waitcnt vmcnt(8)
    v_readfirstlane_b32 s27, v28
    s_mov_b32 s34, 0
NG_8:
    s_cmp_lg_u32 s27, 0
    s_cbranch_scc1 NG_8_x
    s_add_u32 s34, s34, 1
    s_cmp_ge_u32 s34, 16384
    s_cbranch_scc1 NG_8_x
    buffer_load_dword v28, v2, s[60:63], 0 offen sc1
    s_waitcnt vmcnt(0)
    v_readfirstlane_b32 s27, v28
    s_branch NG_8
NG_8_x:
    v_mov_b32 v17, s27
    v_mov_b32 v19, s27
    s_lshl_b32 s32, s25, 1
    s_add_u32 s32, s32, s23
    s_mul_i32 s0, s32, 7168
    s_add_u32 s0, s0, 0x1610000
    s_lshl_b32 s32, s4, 1
    s_add_u32 s32, s32, s22
    s_lshl_b32 s32, s32, 9
    s_add_u32 s32, s32, s0
    s_mov_b32 exec_hi, 0
    buffer_store_dwordx4 v[16:19], v4, s[16:19], s32 offen sc1
    s_mov_b32 exec_hi, -1
    s_add_u32 s1, s0, 4096
    s_waitcnt lgkmcnt(0)
    s_add_u32 m0, s30, 0
    s_nop 0
    buffer_load_dwordx4 v5, s[8:11], s31 offen offset:0 lds
    buffer_load_dwordx4 v6, s[8:11], s31 offen offset:1024 lds
    buffer_load_dwordx4 v7, s[8:11], s31 offen offset:2048 lds
    buffer_load_dwordx4 v8, s[8:11], s31 offen offset:3072 lds
    s_add_u32 s31, s31, s29
    s_cmp_ge_u32 s31, s33
    s_cselect_b32 s31, s3, s31
    s_add_u32 m0, s30, 4096
    s_nop 0
    buffer_load_dwordx4 v5, s[8:11], s31 offen offset:0 lds
    buffer_load_dwordx4 v6, s[8:11], s31 offen offset:1024 lds
    buffer_load_dwordx4 v7, s[8:11], s31 offen offset:2048 lds
    buffer_load_dwordx4 v8, s[8:11], s31 offen offset:3072 lds
    s_add_u32 s31, s31, s29
    s_cmp_ge_u32 s31, s33
    s_cselect_b32 s31, s3, s31
    s_lshl_b32 s32, s6, 13
    s_add_u32 s32, s32, s5
    v_add_u32 v13, s32, v15
    v_xor_b32 v14, 64, v13
    s_add_u32 s6, s6, 1
    s_and_b32 s6, s6, 3
    s_waitcnt vmcnt(9)
.p2align 3
    v_mfma_f32_16x16x32_bf16 v[128:131], v[96:99], v[64:67], 0
    ds_read_b64_tr_b16 v[224:225], v9 offset:0
    v_mfma_f32_16x16x32_bf16 v[128:131], v[100:103], v[68:71], v[128:131]
    ds_read_b64_tr_b16 v[226:227], v9 offset:512
    v_mfma_f32_16x16x32_bf16 v[132:135], v[96:99], v[72:75], 0
    ds_read_b64_tr_b16 v[228:229], v9 offset:4096
    v_mfma_f32_16x16x32_bf16 v[132:135], v[100:103], v[76:79], v[132:135]
    ds_read_b64_tr_b16 v[230:231], v9 offset:4608
    v_mfma_f32_16x16x32_bf16 v[136:139], v[96:99], v[80:83], 0
    ds_read_b64_tr_b16 v[232:233], v10 offset:0
    v_mfma_f32_16x16x32_bf16 v[136:139], v[100:103], v[84:87], v[136:139]
    ds_read_b64_tr_b16 v[234:235], v10 offset:512
    v_mfma_f32_16x16x32_bf16 v[140:143], v[96:99], v[88:91], 0
    ds_read_b64_tr_b16 v[236:237], v10 offset:4096
    v_mfma_f32_16x16x32_bf16 v[140:143], v[100:103], v[92:95], v[140:143]
    ds_read_b64_tr_b16 v[238:239], v10 offset:4608
    v_mfma_f32_16x16x32_bf16 v[144:147], v[104:107], v[64:67], 0
    ds_read_b64_tr_b16 v[240:241], v11 offset:0
    v_mfma_f32_16x16x32_bf16 v[144:147], v[108:111], v[68:71], v[144:147]
    ds_read_b64_tr_b16 v[242:243], v11 offset:512
    v_mfma_f32_16x16x32_bf16 v[148:151], v[104:107], v[72:75], 0
    ds_read_b64_tr_b16 v[244:245], v11 offset:4096
    v_mfma_f32_16x16x32_bf16 v[148:151], v[108:111], v[76:79], v[148:151]
    ds_read_b64_tr_b16 v[246:247], v11 offset:4608
    v_mfma_f32_16x16x32_bf16 v[152:155], v[104:107], v[80:83], 0
    s_waitcnt lgkmcnt(3)
    s_nop 0
    ds_read_b64_tr_b16 v[248:249], v12 offset:0
    v_mfma_f32_16x16x32_bf16 v[152:155], v[108:111], v[84:87], v[152:155]
    ds_read_b64_tr_b16 v[250:251], v12 offset:512
    v_mfma_f32_16x16x32_bf16 v[156:159], v[104:107], v[88:91], 0
    ds_read_b64_tr_b16 v[252:253], v12 offset:4096
    v_mfma_f32_16x16x32_bf16 v[156:159], v[108:111], v[92:95], v[156:159]
    ds_read_b64_tr_b16 v[254:255], v12 offset:4608
    v_mfma_f32_16x16x32_bf16 v[160:163], v[112:115], v[64:67], 0
    ds_read_b128 v[32:35], v13 offset:0
    v_mfma_f32_16x16x32_bf16 v[160:163], v[116:119], v[68:71], v[160:163]
    ds_read_b128 v[36:39], v14 offset:0
    v_mfma_f32_16x16x32_bf16 v[164:167], v[112:115], v[72:75], 0
    ds_read_b128 v[40:43], v13 offset:2048
    v_mfma_f32_16x16x32_bf16 v[164:167], v[116:119], v[76:79], v[164:167]
    ds_read_b128 v[44:47], v14 offset:2048
    v_mfma_f32_16x16x32_bf16 v[168:171], v[112:115], v[80:83], 0
    ds_read_b128 v[48:51], v13 offset:4096
    v_mfma_f32_16x16x32_bf16 v[168:171], v[116:119], v[84:87], v[168:171]
    ds_read_b128 v[52:55], v14 offset:4096
    v_mfma_f32_16x16x32_bf16 v[172:175], v[112:115], v[88:91], 0
    ds_read_b128 v[56:59], v13 offset:6144
    v_mfma_f32_16x16x32_bf16 v[172:175], v[116:119], v[92:95], v[172:175]
    ds_read_b128 v[60:63], v14 offset:6144
    v_mfma_f32_16x16x32_bf16 v[176:179], v[120:123], v[64:67], 0
    v_mfma_f32_16x16x32_bf16 v[176:179], v[124:127], v[68:71], v[176:179]
    v_mfma_f32_16x16x32_bf16 v[180:183], v[120:123], v[72:75], 0
    v_mfma_f32_16x16x32_bf16 v[180:183], v[124:127], v[76:79], v[180:183]
    v_mfma_f32_16x16x32_bf16 v[184:187], v[120:123], v[80:83], 0
    v_mfma_f32_16x16x32_bf16 v[184:187], v[124:127], v[84:87], v[184:187]
    v_mfma_f32_16x16x32_bf16 v[188:191], v[120:123], v[88:91], 0
    v_mfma_f32_16x16x32_bf16 v[188:191], v[124:127], v[92:95], v[188:191]
    s_waitcnt lgkmcnt(0)
    s_add_u32 m0, s30, -32768
    s_nop 0
    buffer_load_dwordx4 v5, s[8:11], s31 offen offset:0 lds
    buffer_load_dwordx4 v6, s[8:11], s31 offen offset:1024 lds
    buffer_load_dwordx4 v7, s[8:11], s31 offen offset:2048 lds
    buffer_load_dwordx4 v8, s[8:11], s31 offen offset:3072 lds
    s_add_u32 s31, s31, s29
    s_cmp_ge_u32 s31, s33
    s_cselect_b32 s31, s3, s31
    s_add_u32 m0, s30, -28672
    s_nop 0
    buffer_load_dwordx4 v5, s[8:11], s31 offen offset:0 lds
    buffer_load_dwordx4 v6, s[8:11], s31 offen offset:1024 lds
    buffer_load_dwordx4 v7, s[8:11], s31 offen offset:2048 lds
    buffer_load_dwordx4 v8, s[8:11], s31 offen offset:3072 lds
    s_add_u32 s31, s31, s29
    s_cmp_ge_u32 s31, s33
    s_cselect_b32 s31, s3, s31
    s_lshl_b32 s32, s6, 13
    s_add_u32 s32, s32, s5
    v_add_u32 v13, s32, v15
    v_xor_b32 v14, 64, v13
    s_add_u32 s6, s6, 1
    s_and_b32 s6, s6, 3
    s_waitcnt vmcnt(8)
.p2align 3
    v_mfma_f32_16x16x32_bf16 v[128:131], v[224:227], v[32:35], v[128:131]
    ds_read_b64_tr_b16 v[96:97], v9 offset:32768
    v_mfma_f32_16x16x32_bf16 v[128:131], v[228:231], v[36:39], v[128:131]
    ds_read_b64_tr_b16 v[98:99], v9 offset:33280
    v_mfma_f32_16x16x32_bf16 v[132:135], v[224:227], v[40:43], v[132:135]
    ds_read_b64_tr_b16 v[100:101], v9 offset:36864
    v_mfma_f32_16x16x32_bf16 v[132:135], v[228:231], v[44:47], v[132:135]
    ds_read_b64_tr_b16 v[102:103], v9 offset:37376
    v_mfma_f32_16x16x32_bf16 v[136:139], v[224:227], v[48:51], v[136:139]
    ds_read_b64_tr_b16 v[104:105], v10 offset:32768
    v_mfma_f32_16x16x32_bf16 v[136:139], v[228:231], v[52:55], v[136:139]
    ds_read_b64_tr_b16 v[106:107], v10 offset:33280
    v_mfma_f32_16x16x32_bf16 v[140:143], v[224:227], v[56:59], v[140:143]
    ds_read_b64_tr_b16 v[108:109], v10 offset:36864
    v_mfma_f32_16x16x32_bf16 v[140:143], v[228:231], v[60:63], v[140:143]
    ds_read_b64_tr_b16 v[110:111], v10 offset:37376
    v_mfma_f32_16x16x32_bf16 v[144:147], v[232:235], v[32:35], v[144:147]
    ds_read_b64_tr_b16 v[112:113], v11 offset:32768
    v_mfma_f32_16x16x32_bf16 v[144:147], v[236:239], v[36:39], v[144:147]
    ds_read_b64_tr_b16 v[114:115], v11 offset:33280
    v_mfma_f32_16x16x32_bf16 v[148:151], v[232:235], v[40:43], v[148:151]
    ds_read_b64_tr_b16 v[116:117], v11 offset:36864
    v_mfma_f32_16x16x32_bf16 v[148:151], v[236:239], v[44:47], v[148:151]
    ds_read_b64_tr_b16 v[118:119], v11 offset:37376
    v_mfma_f32_16x16x32_bf16 v[152:155], v[232:235], v[48:51], v[152:155]
    s_waitcnt lgkmcnt(3)
    s_nop 0
    ds_read_b64_tr_b16 v[120:121], v12 offset:32768
    v_mfma_f32_16x16x32_bf16 v[152:155], v[236:239], v[52:55], v[152:155]
    ds_read_b64_tr_b16 v[122:123], v12 offset:33280
    v_mfma_f32_16x16x32_bf16 v[156:159], v[232:235], v[56:59], v[156:159]
    ds_read_b64_tr_b16 v[124:125], v12 offset:36864
    v_mfma_f32_16x16x32_bf16 v[156:159], v[236:239], v[60:63], v[156:159]
    ds_read_b64_tr_b16 v[126:127], v12 offset:37376
    v_mfma_f32_16x16x32_bf16 v[160:163], v[240:243], v[32:35], v[160:163]
    ds_read_b128 v[64:67], v13 offset:0
    v_mfma_f32_16x16x32_bf16 v[160:163], v[244:247], v[36:39], v[160:163]
    ds_read_b128 v[68:71], v14 offset:0
    v_mfma_f32_16x16x32_bf16 v[164:167], v[240:243], v[40:43], v[164:167]
    ds_read_b128 v[72:75], v13 offset:2048
    v_mfma_f32_16x16x32_bf16 v[164:167], v[244:247], v[44:47], v[164:167]
    ds_read_b128 v[76:79], v14 offset:2048
    v_mfma_f32_16x16x32_bf16 v[168:171], v[240:243], v[48:51], v[168:171]
    ds_read_b128 v[80:83], v13 offset:4096
    v_mfma_f32_16x16x32_bf16 v[168:171], v[244:247], v[52:55], v[168:171]
    ds_read_b128 v[84:87], v14 offset:4096
    v_mfma_f32_16x16x32_bf16 v[172:175], v[240:243], v[56:59], v[172:175]
    ds_read_b128 v[88:91], v13 offset:6144
    v_mfma_f32_16x16x32_bf16 v[172:175], v[244:247], v[60:63], v[172:175]
    ds_read_b128 v[92:95], v14 offset:6144
    v_mfma_f32_16x16x32_bf16 v[176:179], v[248:251], v[32:35], v[176:179]
    v_mfma_f32_16x16x32_bf16 v[176:179], v[252:255], v[36:39], v[176:179]
    v_mfma_f32_16x16x32_bf16 v[180:183], v[248:251], v[40:43], v[180:183]
    v_mfma_f32_16x16x32_bf16 v[180:183], v[252:255], v[44:47], v[180:183]
    v_mfma_f32_16x16x32_bf16 v[184:187], v[248:251], v[48:51], v[184:187]
    v_mfma_f32_16x16x32_bf16 v[184:187], v[252:255], v[52:55], v[184:187]
    v_mfma_f32_16x16x32_bf16 v[188:191], v[248:251], v[56:59], v[188:191]
    v_mfma_f32_16x16x32_bf16 v[188:191], v[252:255], v[60:63], v[188:191]
    s_lshl_b32 s32, s6, 13
    s_add_u32 s32, s32, s5
    v_add_u32 v13, s32, v15
    v_xor_b32 v14, 64, v13
    s_add_u32 s6, s6, 1
    s_and_b32 s6, s6, 3
    s_waitcnt vmcnt(0) lgkmcnt(0)
.p2align 3
    v_mfma_f32_16x16x32_bf16 v[128:131], v[96:99], v[64:67], v[128:131]
    ds_read_b64_tr_b16 v[224:225], v9 offset:0
    v_mfma_f32_16x16x32_bf16 v[128:131], v[100:103], v[68:71], v[128:131]
    ds_read_b64_tr_b16 v[226:227], v9 offset:512
    v_mfma_f32_16x16x32_bf16 v[132:135], v[96:99], v[72:75], v[132:135]
    ds_read_b64_tr_b16 v[228:229], v9 offset:4096
    v_mfma_f32_16x16x32_bf16 v[132:135], v[100:103], v[76:79], v[132:135]
    ds_read_b64_tr_b16 v[230:231], v9 offset:4608
    v_mfma_f32_16x16x32_bf16 v[136:139], v[96:99], v[80:83], v[136:139]
    ds_read_b64_tr_b16 v[232:233], v10 offset:0
    v_mfma_f32_16x16x32_bf16 v[136:139], v[100:103], v[84:87], v[136:139]
    ds_read_b64_tr_b16 v[234:235], v10 offset:512
    v_mfma_f32_16x16x32_bf16 v[140:143], v[96:99], v[88:91], v[140:143]
    ds_read_b64_tr_b16 v[236:237], v10 offset:4096
    v_mfma_f32_16x16x32_bf16 v[140:143], v[100:103], v[92:95], v[140:143]
    ds_read_b64_tr_b16 v[238:239], v10 offset:4608
    v_mfma_f32_16x16x32_bf16 v[144:147], v[104:107], v[64:67], v[144:147]
    ds_read_b64_tr_b16 v[240:241], v11 offset:0
    v_mfma_f32_16x16x32_bf16 v[144:147], v[108:111], v[68:71], v[144:147]
    ds_read_b64_tr_b16 v[242:243], v11 offset:512
    v_mfma_f32_16x16x32_bf16 v[148:151], v[104:107], v[72:75], v[148:151]
    ds_read_b64_tr_b16 v[244:245], v11 offset:4096
    v_mfma_f32_16x16x32_bf16 v[148:151], v[108:111], v[76:79], v[148:151]
    ds_read_b64_tr_b16 v[246:247], v11 offset:4608
    v_mfma_f32_16x16x32_bf16 v[152:155], v[104:107], v[80:83], v[152:155]
    s_waitcnt lgkmcnt(3)
    s_nop 0
    ds_read_b64_tr_b16 v[248:249], v12 offset:0
    v_mfma_f32_16x16x32_bf16 v[152:155], v[108:111], v[84:87], v[152:155]
    ds_read_b64_tr_b16 v[250:251], v12 offset:512
    v_mfma_f32_16x16x32_bf16 v[156:159], v[104:107], v[88:91], v[156:159]
    ds_read_b64_tr_b16 v[252:253], v12 offset:4096
    v_mfma_f32_16x16x32_bf16 v[156:159], v[108:111], v[92:95], v[156:159]
    ds_read_b64_tr_b16 v[254:255], v12 offset:4608
    v_mfma_f32_16x16x32_bf16 v[160:163], v[112:115], v[64:67], v[160:163]
    ds_read_b128 v[32:35], v13 offset:0
    v_mfma_f32_16x16x32_bf16 v[160:163], v[116:119], v[68:71], v[160:163]
    ds_read_b128 v[36:39], v14 offset:0
    v_mfma_f32_16x16x32_bf16 v[164:167], v[112:115], v[72:75], v[164:167]
    ds_read_b128 v[40:43], v13 offset:2048
    v_mfma_f32_16x16x32_bf16 v[164:167], v[116:119], v[76:79], v[164:167]
    ds_read_b128 v[44:47], v14 offset:2048
    v_mfma_f32_16x16x32_bf16 v[168:171], v[112:115], v[80:83], v[168:171]
    ds_read_b128 v[48:51], v13 offset:4096
    v_mfma_f32_16x16x32_bf16 v[168:171], v[116:119], v[84:87], v[168:171]
    ds_read_b128 v[52:55], v14 offset:4096
    v_mfma_f32_16x16x32_bf16 v[172:175], v[112:115], v[88:91], v[172:175]
    ds_read_b128 v[56:59], v13 offset:6144
    v_mfma_f32_16x16x32_bf16 v[172:175], v[116:119], v[92:95], v[172:175]
    ds_read_b128 v[60:63], v14 offset:6144
    v_mfma_f32_16x16x32_bf16 v[176:179], v[120:123], v[64:67], v[176:179]
    v_mfma_f32_16x16x32_bf16 v[176:179], v[124:127], v[68:71], v[176:179]
    v_mfma_f32_16x16x32_bf16 v[180:183], v[120:123], v[72:75], v[180:183]
    v_mfma_f32_16x16x32_bf16 v[180:183], v[124:127], v[76:79], v[180:183]
    v_mfma_f32_16x16x32_bf16 v[184:187], v[120:123], v[80:83], v[184:187]
    v_mfma_f32_16x16x32_bf16 v[184:187], v[124:127], v[84:87], v[184:187]
    v_mfma_f32_16x16x32_bf16 v[188:191], v[120:123], v[88:91], v[188:191]
    v_mfma_f32_16x16x32_bf16 v[188:191], v[124:127], v[92:95], v[188:191]
    s_lshl_b32 s28, s25, 7
    s_add_u32 s28, s28, 0x1691000
    buffer_load_dwordx4 v[64:67], v4, s[16:19], s0 offen offset:0 sc1
    buffer_load_dwordx4 v[68:71], v4, s[16:19], s0 offen offset:1024 sc1
    buffer_load_dwordx4 v[72:75], v4, s[16:19], s0 offen offset:2048 sc1
    buffer_load_dwordx4 v[76:79], v4, s[16:19], s0 offen offset:3072 sc1
    buffer_load_dwordx4 v[80:83], v4, s[16:19], s1 offen offset:0 sc1
    buffer_load_dwordx4 v[84:87], v4, s[16:19], s1 offen offset:1024 sc1
    buffer_load_dwordx4 v[88:91], v4, s[16:19], s1 offen offset:2048 sc1
    v_add_u32 v16, s30, v4
    v_xor_b32 v17, 0x2000, v16
    s_waitcnt lgkmcnt(0)
    v_mfma_f32_16x16x32_bf16 v[160:163], v[240:243], v[32:35], v[160:163]
    v_mfma_f32_16x16x32_bf16 v[160:163], v[244:247], v[36:39], v[160:163]
    v_mfma_f32_16x16x32_bf16 v[164:167], v[240:243], v[40:43], v[164:167]
    v_mfma_f32_16x16x32_bf16 v[164:167], v[244:247], v[44:47], v[164:167]
    v_mfma_f32_16x16x32_bf16 v[168:171], v[240:243], v[48:51], v[168:171]
    v_mfma_f32_16x16x32_bf16 v[168:171], v[244:247], v[52:55], v[168:171]
    v_mfma_f32_16x16x32_bf16 v[172:175], v[240:243], v[56:59], v[172:175]
    v_mfma_f32_16x16x32_bf16 v[172:175], v[244:247], v[60:63], v[172:175]
    v_mfma_f32_16x16x32_bf16 v[176:179], v[248:251], v[32:35], v[176:179]
    v_mfma_f32_16x16x32_bf16 v[176:179], v[252:255], v[36:39], v[176:179]
    v_mfma_f32_16x16x32_bf16 v[180:183], v[248:251], v[40:43], v[180:183]
    v_mfma_f32_16x16x32_bf16 v[180:183], v[252:255], v[44:47], v[180:183]
    v_mfma_f32_16x16x32_bf16 v[184:187], v[248:251], v[48:51], v[184:187]
    v_mfma_f32_16x16x32_bf16 v[184:187], v[252:255], v[52:55], v[184:187]
    v_mfma_f32_16x16x32_bf16 v[188:191], v[248:251], v[56:59], v[188:191]
    v_mfma_f32_16x16x32_bf16 v[188:191], v[252:255], v[60:63], v[188:191]
    v_mfma_f32_16x16x32_bf16 v[128:131], v[224:227], v[32:35], v[128:131]
    v_mfma_f32_16x16x32_bf16 v[128:131], v[228:231], v[36:39], v[128:131]
    ds_write_b128 v16, v[160:163] offset:0
    v_mfma_f32_16x16x32_bf16 v[132:135], v[224:227], v[40:43], v[132:135]
    v_mfma_f32_16x16x32_bf16 v[132:135], v[228:231], v[44:47], v[132:135]
    ds_write_b128 v16, v[164:167] offset:1024
    v_mfma_f32_16x16x32_bf16 v[136:139], v[224:227], v[48:51], v[136:139]
    v_mfma_f32_16x16x32_bf16 v[136:139], v[228:231], v[52:55], v[136:139]
    ds_write_b128 v16, v[168:171] offset:2048
    v_mfma_f32_16x16x32_bf16 v[140:143], v[224:227], v[56:59], v[140:143]
    v_mfma_f32_16x16x32_bf16 v[140:143], v[228:231], v[60:63], v[140:143]
    ds_write_b128 v16, v[172:175] offset:3072
    v_mfma_f32_16x16x32_bf16 v[144:147], v[232:235], v[32:35], v[144:147]
    v_mfma_f32_16x16x32_bf16 v[144:147], v[236:239], v[36:39], v[144:147]
    ds_write_b128 v16, v[176:179] offset:4096
    v_mfma_f32_16x16x32_bf16 v[148:151], v[232:235], v[40:43], v[148:151]
    v_mfma_f32_16x16x32_bf16 v[148:151], v[236:239], v[44:47], v[148:151]
    ds_write_b128 v16, v[180:183] offset:5120
    v_mfma_f32_16x16x32_bf16 v[152:155], v[232:235], v[48:51], v[152:155]
    v_mfma_f32_16x16x32_bf16 v[152:155], v[236:239], v[52:55], v[152:155]
    ds_write_b128 v16, v[184:187] offset:6144
    v_mfma_f32_16x16x32_bf16 v[156:159], v[232:235], v[56:59], v[156:159]
    v_mfma_f32_16x16x32_bf16 v[156:159], v[236:239], v[60:63], v[156:159]
    ds_write_b128 v16, v[188:191] offset:7168
    v_and_b32 v60, 15, v1
    v_lshlrev_b32 v60, 7, v60
    v_bfe_u32 v61, v1, 1, 1
    v_lshl_add_u32 v60, v61, 5, v60
    v_bfe_u32 v61, v1, 3, 1
    v_xor_b32 v61, s23, v61
    v_lshl_add_u32 v60, v61, 6, v60
    v_lshrrev_b32 v61, 4, v1
    v_lshl_add_u32 v60, v61, 3, v60
    s_sub_u32 s32, s30, 32768
    v_add_u32 v60, s32, v60
    v_xor_b32 v61, 32, v60
    v_xor_b32 v62, 64, v60
    v_xor_b32 v63, 96, v60
    s_waitcnt lgkmcnt(0)
    s_mov_b64 exec, 1
    ds_add_u32 v2, v3 offset:16
    s_mov_b64 exec, -1
    s_mov_b32 s34, 0
    s_waitcnt vmcnt(0)
SP_9:
    v_xor_b32 v20, s27, v65
    v_xor_b32 v21, s27, v67
    v_or_b32 v20, v20, v21
    v_xor_b32 v21, s27, v69
    v_or_b32 v20, v20, v21
    v_xor_b32 v21, s27, v71
    v_or_b32 v20, v20, v21
    v_xor_b32 v21, s27, v73
    v_or_b32 v20, v20, v21
    v_xor_b32 v21, s27, v75
    v_or_b32 v20, v20, v21
    v_xor_b32 v21, s27, v77
    v_or_b32 v20, v20, v21
    v_xor_b32 v21, s27, v79
    v_or_b32 v20, v20, v21
    v_xor_b32 v21, s27, v81
    v_or_b32 v20, v20, v21
    v_xor_b32 v21, s27, v83
    v_or_b32 v20, v20, v21
    v_xor_b32 v21, s27, v85
    v_or_b32 v20, v20, v21
    v_xor_b32 v21, s27, v87
    v_or_b32 v20, v20, v21
    v_xor_b32 v21, s27, v89
    v_or_b32 v20, v20, v21
    v_xor_b32 v21, s27, v91
    v_or_b32 v20, v20, v21
    v_cmp_ne_u32 vcc, 0, v20
    s_add_u32 s34, s34, 1
    s_cmp_ge_u32 s34, 8192
    s_cbranch_scc1 SP_9_x
    s_cbranch_vccz SP_9_x
    buffer_load_dwordx4 v[64:67], v4, s[16:19], s0 offen offset:0 sc1
    buffer_load_dwordx4 v[68:71], v4, s[16:19], s0 offen offset:1024 sc1
    buffer_load_dwordx4 v[72:75], v4, s[16:19], s0 offen offset:2048 sc1
    buffer_load_dwordx4 v[76:79], v4, s[16:19], s0 offen offset:3072 sc1
    buffer_load_dwordx4 v[80:83], v4, s[16:19], s1 offen offset:0 sc1
    buffer_load_dwordx4 v[84:87], v4, s[16:19], s1 offen offset:1024 sc1
    buffer_load_dwordx4 v[88:91], v4, s[16:19], s1 offen offset:2048 sc1
    s_waitcnt vmcnt(0)
    s_branch SP_9
SP_9_x:
    v_mov_b32 v32, v64
    v_mov_b32 v34, v66
    v_add_f32 v32, v32, v68
    v_add_f32 v34, v34, v70
    v_add_f32 v32, v32, v72
    v_add_f32 v34, v34, v74
    v_add_f32 v32, v32, v76
    v_add_f32 v34, v34, v78
    v_add_f32 v32, v32, v80
    v_add_f32 v34, v34, v82
    v_add_f32 v32, v32, v84
    v_add_f32 v34, v34, v86
    v_add_f32 v32, v32, v88
    v_add_f32 v34, v34, v90
    v_mov_b32 v33, v32
    v_mov_b32 v35, v34
    s_nop 1
    v_permlane32_swap_b32 v32, v33
    v_permlane32_swap_b32 v34, v35
    s_nop 1
    v_add_f32 v32, v32, v33
    v_add_f32 v34, v34, v35
    v_mul_f32 v32, 0x3a924925, v32
    v_mul_f32 v34, 0x3a924925, v34
    v_fma_f32 v34, -v32, v32, v34
    v_max_f32 v34, 0, v34
    v_add_f32 v34, 0x3727c5ac, v34
    v_rsq_f32 v36, v34
    s_nop 0
    v_mul_f32 v40, v32, v36
    v_sub_f32 v40, 0, v40
    v_mov_b32 v38, v36
    v_mov_b32 v42, v40
    s_nop 1
    v_permlane16_swap_b32 v36, v38
    v_permlane16_swap_b32 v40, v42
    s_waitcnt lgkmcnt(0)
    s_nop 0
    v_pk_fma_f32 v[192:193], v[192:193], v[36:37], v[40:41] op_sel_hi:[1,0,0]
    v_pk_fma_f32 v[194:195], v[194:195], v[36:37], v[40:41] op_sel_hi:[1,0,0]
    v_cvt_pk_bf16_f32 v44, v192, v193
    v_cvt_pk_bf16_f32 v45, v194, v195
    ds_write_b64 v60, v[44:45] offset:0
    v_pk_fma_f32 v[196:197], v[196:197], v[38:39], v[42:43] op_sel_hi:[1,0,0]
    v_pk_fma_f32 v[198:199], v[198:199], v[38:39], v[42:43] op_sel_hi:[1,0,0]
    v_cvt_pk_bf16_f32 v46, v196, v197
    v_cvt_pk_bf16_f32 v47, v198, v199
    ds_write_b64 v60, v[46:47] offset:2048
    v_pk_fma_f32 v[200:201], v[200:201], v[36:37], v[40:41] op_sel_hi:[1,0,0]
    v_pk_fma_f32 v[202:203], v[202:203], v[36:37], v[40:41] op_sel_hi:[1,0,0]
    v_cvt_pk_bf16_f32 v48, v200, v201
    v_cvt_pk_bf16_f32 v49, v202, v203
    ds_write_b64 v61, v[48:49] offset:0
    v_pk_fma_f32 v[204:205], v[204:205], v[38:39], v[42:43] op_sel_hi:[1,0,0]
    v_pk_fma_f32 v[206:207], v[206:207], v[38:39], v[42:43] op_sel_hi:[1,0,0]
    v_cvt_pk_bf16_f32 v50, v204, v205
    v_cvt_pk_bf16_f32 v51, v206, v207
    ds_write_b64 v61, v[50:51] offset:2048
    v_pk_fma_f32 v[208:209], v[208:209], v[36:37], v[40:41] op_sel_hi:[1,0,0]
    v_pk_fma_f32 v[210:211], v[210:211], v[36:37], v[40:41] op_sel_hi:[1,0,0]
    v_cvt_pk_bf16_f32 v52, v208, v209
    v_cvt_pk_bf16_f32 v53, v210, v211
    ds_write_b64 v62, v[52:53] offset:0
    v_pk_fma_f32 v[212:213], v[212:213], v[38:39], v[42:43] op_sel_hi:[1,0,0]
    v_pk_fma_f32 v[214:215], v[214:215], v[38:39], v[42:43] op_sel_hi:[1,0,0]
    v_cvt_pk_bf16_f32 v54, v212, v213
    v_cvt_pk_bf16_f32 v55, v214, v215
    ds_write_b64 v62, v[54:55] offset:2048
    v_pk_fma_f32 v[216:217], v[216:217], v[36:37], v[40:41] op_sel_hi:[1,0,0]
    v_pk_fma_f32 v[218:219], v[218:219], v[36:37], v[40:41] op_sel_hi:[1,0,0]
    v_cvt_pk_bf16_f32 v56, v216, v217
    v_cvt_pk_bf16_f32 v57, v218, v219
    ds_write_b64 v63, v[56:57] offset:0
    v_pk_fma_f32 v[220:221], v[220:221], v[38:39], v[42:43] op_sel_hi:[1,0,0]
    v_pk_fma_f32 v[222:223], v[222:223], v[38:39], v[42:43] op_sel_hi:[1,0,0]
    v_cvt_pk_bf16_f32 v58, v220, v221
    v_cvt_pk_bf16_f32 v59, v222, v223
    ds_write_b64 v63, v[58:59] offset:2048
    s_lshl_b32 s0, s4, 5
    s_add_u32 s0, s0, s25
    s_lshl_b32 s0, s0, 14
    s_lshl_b32 s32, s22, 13
    s_add_u32 s0, s0, s32
    s_lshl_b32 s32, s23, 10
    s_add_u32 s0, s0, s32
    s_add_u32 s0, s0, 0xa00000
    s_add_u32 s1, s0, 4096
    s_waitcnt lgkmcnt(0)
    ds_read_b64_tr_b16 v[96:97], v9 offset:0
    ds_read_b64_tr_b16 v[98:99], v9 offset:512
    ds_read_b64_tr_b16 v[100:101], v10 offset:0
    ds_read_b64_tr_b16 v[102:103], v10 offset:512
    ds_read_b64_tr_b16 v[104:105], v11 offset:0
    ds_read_b64_tr_b16 v[106:107], v11 offset:512
    ds_read_b64_tr_b16 v[108:109], v12 offset:0
    ds_read_b64_tr_b16 v[110:111], v12 offset:512
    s_waitcnt lgkmcnt(0)
    buffer_store_dwordx4 v[96:99], v4, s[16:19], s0 offen offset:0 sc1
    buffer_store_dwordx4 v[100:103], v4, s[16:19], s0 offen offset:2048 sc1
    buffer_store_dwordx4 v[104:107], v4, s[16:19], s1 offen offset:0 sc1
    buffer_store_dwordx4 v[108:111], v4, s[16:19], s1 offen offset:2048 sc1
    buffer_load_dword v29, v2, s[16:19], s28 offen sc1
    s_mov_b64 exec, 1
    ds_add_u32 v2, v3 offset:0
    s_mov_b64 exec, -1
    s_lshl_b32 s31, s4, 7
    s_lshl_b32 s32, s25, 2
    s_add_u32 s31, s31, s32
    s_add_u32 s31, s31, s7
    s_lshl_b32 s31, s31, 7
    s_add_u32 s31, s31, 0x16a0000
    v_mov_b32 v24, 0xc0135761
    v_mov_b32 v25, 0xc0135761
    v_mov_b32 v26, 1.0
    v_mov_b32 v27, 1.0
    s_mov_b32 s34, 0
LW_10:
    ds_read_b32 v18, v2 offset:16
    s_waitcnt lgkmcnt(0)
    v_readfirstlane_b32 s35, v18
    s_add_u32 s34, s34, 1
    s_cmp_ge_u32 s34, 131072
    s_cbranch_scc1 LW_10_x
    s_cmp_lt_u32 s35, 4
    s_cbranch_scc1 LW_10
LW_10_x:
    ds_read_b128 v[64:67], v17 offset:0
    ds_read_b128 v[68:71], v17 offset:1024
    ds_read_b128 v[72:75], v17 offset:2048
    ds_read_b128 v[76:79], v17 offset:3072
    ds_read_b128 v[80:83], v17 offset:4096
    ds_read_b128 v[84:87], v17 offset:5120
    ds_read_b128 v[88:91], v17 offset:6144
    ds_read_b128 v[92:95], v17 offset:7168
    s_waitcnt lgkmcnt(0)
    s_mov_b64 exec, 1
    ds_add_u32 v2, v3 offset:16
    s_mov_b64 exec, -1
    v_pk_add_f32 v[128:129], v[128:129], v[64:65]
    v_pk_add_f32 v[130:131], v[130:131], v[66:67]
    v_pk_add_f32 v[132:133], v[132:133], v[68:69]
    v_pk_add_f32 v[134:135], v[134:135], v[70:71]
    v_pk_add_f32 v[136:137], v[136:137], v[72:73]
    v_pk_add_f32 v[138:139], v[138:139], v[74:75]
    v_pk_add_f32 v[140:141], v[140:141], v[76:77]
    v_pk_add_f32 v[142:143], v[142:143], v[78:79]
    v_pk_add_f32 v[144:145], v[144:145], v[80:81]
    v_pk_add_f32 v[146:147], v[146:147], v[82:83]
    v_pk_add_f32 v[148:149], v[148:149], v[84:85]
    v_pk_add_f32 v[150:151], v[150:151], v[86:87]
    v_pk_add_f32 v[152:153], v[152:153], v[88:89]
    v_pk_add_f32 v[154:155], v[154:155], v[90:91]
    v_pk_add_f32 v[156:157], v[156:157], v[92:93]
    v_pk_add_f32 v[158:159], v[158:159], v[94:95]
    v_pk_mul_f32 v[16:17], v[128:129], v[128:129]
    v_pk_mul_f32 v[18:19], v[130:131], v[130:131]
    v_pk_mul_f32 v[20:21], v[132:133], v[132:133]
    v_pk_mul_f32 v[22:23], v[134:135], v[134:135]
    v_pk_fma_f32 v[16:17], v[16:17], s[20:21], v[24:25]
    v_pk_fma_f32 v[18:19], v[18:19], s[20:21], v[24:25]
    v_pk_fma_f32 v[20:21], v[20:21], s[20:21], v[24:25]
    v_pk_fma_f32 v[22:23], v[22:23], s[20:21], v[24:25]
    v_pk_mul_f32 v[16:17], v[16:17], v[128:129]
    v_pk_mul_f32 v[18:19], v[18:19], v[130:131]
    v_pk_mul_f32 v[20:21], v[20:21], v[132:133]
    v_pk_mul_f32 v[22:23], v[22:23], v[134:135]
    v_exp_f32 v16, v16
    v_exp_f32 v17, v17
    v_exp_f32 v18, v18
    v_exp_f32 v19, v19
    v_exp_f32 v20, v20
    v_exp_f32 v21, v21
    v_exp_f32 v22, v22
    v_exp_f32 v23, v23
    v_pk_add_f32 v[16:17], v[16:17], v[26:27]
    v_pk_add_f32 v[18:19], v[18:19], v[26:27]
    v_pk_add_f32 v[20:21], v[20:21], v[26:27]
    v_pk_add_f32 v[22:23], v[22:23], v[26:27]
    v_rcp_f32 v16, v16
    v_rcp_f32 v17, v17
    v_rcp_f32 v18, v18
    v_rcp_f32 v19, v19
    v_rcp_f32 v20, v20
    v_rcp_f32 v21, v21
    v_rcp_f32 v22, v22
    v_rcp_f32 v23, v23
    v_pk_mul_f32 v[128:129], v[128:129], v[16:17]
    v_pk_mul_f32 v[130:131], v[130:131], v[18:19]
    v_pk_mul_f32 v[132:133], v[132:133], v[20:21]
    v_pk_mul_f32 v[134:135], v[134:135], v[22:23]
    s_mov_b32 s12, s46
    s_mov_b32 s13, s47
    s_mov_b32 s14, 0x800000
    s_mov_b32 s15, 0x20000
    s_mov_b32 s8, s48
    s_mov_b32 s9, s49
    s_mov_b32 s10, 0x1000
    s_mov_b32 s11, 0x20000
    v_lshrrev_b32 v5, 3, v1
    v_and_b32 v6, 7, v1
    v_lshrrev_b32 v7, 4, v1
    v_xor_b32 v6, v6, v7
    s_lshl_b32 s32, s25, 6
    v_add_u32 v5, s32, v5
    v_lshlrev_b32 v5, 12, v5
    v_lshl_add_u32 v5, v6, 4, v5
    v_xor_b32 v6, 64, v5
    v_add_u32 v6, 31744, v6
    v_add_u32 v7, 63488, v5
    v_add_u32 v8, 63488, v6
    s_mov_b32 s6, 0
    s_lshl_b32 s3, s7, 10
    v_and_b32 v48, 15, v1
    v_lshlrev_b32 v49, 1, v48
    v_lshlrev_b32 v48, 2, v48
    s_waitcnt vmcnt(0)
    v_mov_b32 v28, s27
    s_mov_b64 exec, 1
    buffer_store_dword v28, v2, s[16:19], s31 offen sc1
    s_mov_b64 exec, -1
    v_cmp_ne_u32 vcc, s27, v29
    s_nop 4
    s_cbranch_vccz L_G0OK
    s_mov_b32 s34, 0
PL_11:
    buffer_load_dword v29, v2, s[16:19], s28 offen sc1
    s_waitcnt vmcnt(0)
    v_xor_b32 v29, s27, v29
    v_cmp_ne_u32 vcc, 0, v29
    s_add_u32 s34, s34, 1
    s_cmp_ge_u32 s34, 16384
    s_cbranch_scc1 PL_11_x
    s_cbranch_vccz PL_11_x
    s_sleep 4
    s_branch PL_11
PL_11_x:
L_G0OK:
    s_lshl_b32 s28, s25, 7
    s_lshl_b32 s29, s25, 8
    s_add_u32 s29, s29, 0x1600000
    buffer_load_ushort v32, v49, s[8:11], s28 offen offset:0
    buffer_load_dword v40, v48, s[16:19], s29 offen offset:0 sc1
    buffer_load_ushort v34, v49, s[8:11], s28 offen offset:32
    buffer_load_dword v42, v48, s[16:19], s29 offen offset:64 sc1
    buffer_load_ushort v36, v49, s[8:11], s28 offen offset:64
    buffer_load_dword v44, v48, s[16:19], s29 offen offset:128 sc1
    buffer_load_ushort v38, v49, s[8:11], s28 offen offset:96
    buffer_load_dword v46, v48, s[16:19], s29 offen offset:192 sc1
    s_mov_b32 s34, 0
LW_12:
    ds_read_b32 v29, v2 offset:16
    s_waitcnt lgkmcnt(0)
    v_readfirstlane_b32 s35, v29
    s_add_u32 s34, s34, 1
    s_cmp_ge_u32 s34, 131072
    s_cbranch_scc1 LW_12_x
    s_cmp_lt_u32 s35, 8
    s_cbranch_scc1 LW_12
LW_12_x:
    s_lshl_b32 s31, s6, 7
    s_add_u32 s31, s31, s3
    s_add_u32 m0, s30, 0
    s_add_u32 s32, s31, 0
    buffer_load_dwordx4 v5, s[12:15], s32 offen offset:0 lds
    buffer_load_dwordx4 v6, s[12:15], s32 offen offset:1024 lds
    buffer_load_dwordx4 v7, s[12:15], s32 offen offset:2048 lds
    buffer_load_dwordx4 v8, s[12:15], s32 offen offset:3072 lds
    s_add_u32 m0, s30, 4096
    s_add_u32 s32, s31, 131072
    buffer_load_dwordx4 v5, s[12:15], s32 offen offset:0 lds
    buffer_load_dwordx4 v6, s[12:15], s32 offen offset:1024 lds
    buffer_load_dwordx4 v7, s[12:15], s32 offen offset:2048 lds
    buffer_load_dwordx4 v8, s[12:15], s32 offen offset:3072 lds
    v_pk_mul_f32 v[16:17], v[136:137], v[136:137]
    v_pk_mul_f32 v[18:19], v[138:139], v[138:139]
    v_pk_mul_f32 v[20:21], v[140:141], v[140:141]
    v_pk_mul_f32 v[22:23], v[142:143], v[142:143]
    v_pk_fma_f32 v[16:17], v[16:17], s[20:21], v[24:25]
    v_pk_fma_f32 v[18:19], v[18:19], s[20:21], v[24:25]
    v_pk_fma_f32 v[20:21], v[20:21], s[20:21], v[24:25]
    v_pk_fma_f32 v[22:23], v[22:23], s[20:21], v[24:25]
    v_pk_mul_f32 v[16:17], v[16:17], v[136:137]
    v_pk_mul_f32 v[18:19], v[18:19], v[138:139]
    v_pk_mul_f32 v[20:21], v[20:21], v[140:141]
    v_pk_mul_f32 v[22:23], v[22:23], v[142:143]
    v_exp_f32 v16, v16
    v_exp_f32 v17, v17
    v_exp_f32 v18, v18
    v_exp_f32 v19, v19
    v_exp_f32 v20, v20
    v_exp_f32 v21, v21
    v_exp_f32 v22, v22
    v_exp_f32 v23, v23
    v_pk_add_f32 v[16:17], v[16:17], v[26:27]
    v_pk_add_f32 v[18:19], v[18:19], v[26:27]
    v_pk_add_f32 v[20:21], v[20:21], v[26:27]
    v_pk_add_f32 v[22:23], v[22:23], v[26:27]
    v_rcp_f32 v16, v16
    v_rcp_f32 v17, v17
    v_rcp_f32 v18, v18
    v_rcp_f32 v19, v19
    v_rcp_f32 v20, v20
    v_rcp_f32 v21, v21
    v_rcp_f32 v22, v22
    v_rcp_f32 v23, v23
    v_pk_mul_f32 v[136:137], v[136:137], v[16:17]
    v_pk_mul_f32 v[138:139], v[138:139], v[18:19]
    v_pk_mul_f32 v[140:141], v[140:141], v[20:21]
    v_pk_mul_f32 v[142:143], v[142:143], v[22:23]
    v_pk_mul_f32 v[16:17], v[144:145], v[144:145]
    v_pk_mul_f32 v[18:19], v[146:147], v[146:147]
    v_pk_mul_f32 v[20:21], v[148:149], v[148:149]
    v_pk_mul_f32 v[22:23], v[150:151], v[150:151]
    v_pk_fma_f32 v[16:17], v[16:17], s[20:21], v[24:25]
    v_pk_fma_f32 v[18:19], v[18:19], s[20:21], v[24:25]
    v_pk_fma_f32 v[20:21], v[20:21], s[20:21], v[24:25]
    v_pk_fma_f32 v[22:23], v[22:23], s[20:21], v[24:25]
    v_pk_mul_f32 v[16:17], v[16:17], v[144:145]
    v_pk_mul_f32 v[18:19], v[18:19], v[146:147]
    v_pk_mul_f32 v[20:21], v[20:21], v[148:149]
    v_pk_mul_f32 v[22:23], v[22:23], v[150:151]
    v_exp_f32 v16, v16
    v_exp_f32 v17, v17
    v_exp_f32 v18, v18
    v_exp_f32 v19, v19
    v_exp_f32 v20, v20
    v_exp_f32 v21, v21
    v_exp_f32 v22, v22
    v_exp_f32 v23, v23
    v_pk_add_f32 v[16:17], v[16:17], v[26:27]
    v_pk_add_f32 v[18:19], v[18:19], v[26:27]
    v_pk_add_f32 v[20:21], v[20:21], v[26:27]
    v_pk_add_f32 v[22:23], v[22:23], v[26:27]
    v_rcp_f32 v16, v16
    v_rcp_f32 v17, v17
    v_rcp_f32 v18, v18
    v_rcp_f32 v19, v19
    v_rcp_f32 v20, v20
    v_rcp_f32 v21, v21
    v_rcp_f32 v22, v22
    v_rcp_f32 v23, v23
    v_pk_mul_f32 v[144:145], v[144:145], v[16:17]
    v_pk_mul_f32 v[146:147], v[146:147], v[18:19]
    v_pk_mul_f32 v[148:149], v[148:149], v[20:21]
    v_pk_mul_f32 v[150:151], v[150:151], v[22:23]
    v_pk_mul_f32 v[16:17], v[152:153], v[152:153]
    v_pk_mul_f32 v[18:19], v[154:155], v[154:155]
    v_pk_mul_f32 v[20:21], v[156:157], v[156:157]
    v_pk_mul_f32 v[22:23], v[158:159], v[158:159]
    v_pk_fma_f32 v[16:17], v[16:17], s[20:21], v[24:25]
    v_pk_fma_f32 v[18:19], v[18:19], s[20:21], v[24:25]
    v_pk_fma_f32 v[20:21], v[20:21], s[20:21], v[24:25]
    v_pk_fma_f32 v[22:23], v[22:23], s[20:21], v[24:25]
    v_pk_mul_f32 v[16:17], v[16:17], v[152:153]
    v_pk_mul_f32 v[18:19], v[18:19], v[154:155]
    v_pk_mul_f32 v[20:21], v[20:21], v[156:157]
    v_pk_mul_f32 v[22:23], v[22:23], v[158:159]
    v_exp_f32 v16, v16
    v_exp_f32 v17, v17
    v_exp_f32 v18, v18
    v_exp_f32 v19, v19
    v_exp_f32 v20, v20
    v_exp_f32 v21, v21
    v_exp_f32 v22, v22
    v_exp_f32 v23, v23
    v_pk_add_f32 v[16:17], v[16:17], v[26:27]
    v_pk_add_f32 v[18:19], v[18:19], v[26:27]
    v_pk_add_f32 v[20:21], v[20:21], v[26:27]
    v_pk_add_f32 v[22:23], v[22:23], v[26:27]
    v_rcp_f32 v16, v16
    v_rcp_f32 v17, v17
    v_rcp_f32 v18, v18
    v_rcp_f32 v19, v19
    v_rcp_f32 v20, v20
    v_rcp_f32 v21, v21
    v_rcp_f32 v22, v22
    v_rcp_f32 v23, v23
    v_pk_mul_f32 v[152:153], v[152:153], v[16:17]
    v_pk_mul_f32 v[154:155], v[154:155], v[18:19]
    v_pk_mul_f32 v[156:157], v[156:157], v[20:21]
    v_pk_mul_f32 v[158:159], v[158:159], v[22:23]
    s_lshl_b32 s28, s4, 2
    s_add_u32 s28, s28, s7
    s_lshl_b32 s28, s28, 12
    s_add_u32 s28, s28, 0x16a0000
    v_and_b32 v48, 31, v1
    v_lshlrev_b32 v48, 7, v48
    buffer_load_dword v49, v48, s[16:19], s28 offen sc1
    v_add_u32 v13, s30, v15
    v_xor_b32 v14, 64, v13
    s_add_u32 s32, s7, 0
    s_and_b32 s32, s32, 3
    s_lshl_b32 s32, s32, 12
    v_add_u32 v9, s32, v4
    s_add_u32 s32, s7, 1
    s_and_b32 s32, s32, 3
    s_lshl_b32 s32, s32, 12
    v_add_u32 v10, s32, v4
    s_add_u32 s32, s7, 2
    s_and_b32 s32, s32, 3
    s_lshl_b32 s32, s32, 12
    v_add_u32 v11, s32, v4
    s_add_u32 s32, s7, 3
    s_and_b32 s32, s32, 3
    s_lshl_b32 s32, s32, 12
    v_add_u32 v12, s32, v4
    s_lshl_b32 s33, s4, 5
    s_lshl_b32 s32, s7, 3
    s_add_u32 s33, s33, s32
    s_lshl_b32 s33, s33, 14
    s_add_u32 s0, s33, 0xa00000
    s_mov_b32 s33, s0
    s_waitcnt vmcnt(9)
    v_lshlrev_b32 v32, 16, v32
    v_sub_f32 v40, 1.0, v40
    v_mov_b32 v33, v32
    v_lshlrev_b32 v34, 16, v34
    v_sub_f32 v42, 1.0, v42
    v_mov_b32 v35, v34
    v_lshlrev_b32 v36, 16, v36
    v_sub_f32 v44, 1.0, v44
    v_mov_b32 v37, v36
    v_lshlrev_b32 v38, 16, v38
    v_sub_f32 v46, 1.0, v46
    v_mov_b32 v39, v38
    v_pk_mul_f32 v[128:129], v[128:129], v[40:41] op_sel_hi:[1,0]
    v_pk_mul_f32 v[130:131], v[130:131], v[40:41] op_sel_hi:[1,0]
    v_cvt_pk_bf16_f32 v16, v128, v129
    v_cvt_pk_bf16_f32 v17, v130, v131
    v_mov_b64 v[128:129], v[32:33]
    v_mov_b64 v[130:131], v[32:33]
    v_pk_mul_f32 v[144:145], v[144:145], v[40:41] op_sel_hi:[1,0]
    v_pk_mul_f32 v[146:147], v[146:147], v[40:41] op_sel_hi:[1,0]
    v_cvt_pk_bf16_f32 v18, v144, v145
    v_cvt_pk_bf16_f32 v19, v146, v147
    v_mov_b64 v[144:145], v[32:33]
    v_mov_b64 v[146:147], v[32:33]
    v_pk_mul_f32 v[132:133], v[132:133], v[42:43] op_sel_hi:[1,0]
    v_pk_mul_f32 v[134:135], v[134:135], v[42:43] op_sel_hi:[1,0]
    v_cvt_pk_bf16_f32 v20, v132, v133
    v_cvt_pk_bf16_f32 v21, v134, v135
    v_mov_b64 v[132:133], v[34:35]
    v_mov_b64 v[134:135], v[34:35]
    v_pk_mul_f32 v[148:149], v[148:149], v[42:43] op_sel_hi:[1,0]
    v_pk_mul_f32 v[150:151], v[150:151], v[42:43] op_sel_hi:[1,0]
    v_cvt_pk_bf16_f32 v22, v148, v149
    v_cvt_pk_bf16_f32 v23, v150, v151
    v_mov_b64 v[148:149], v[34:35]
    v_mov_b64 v[150:151], v[34:35]
    v_pk_mul_f32 v[136:137], v[136:137], v[44:45] op_sel_hi:[1,0]
    v_pk_mul_f32 v[138:139], v[138:139], v[44:45] op_sel_hi:[1,0]
    v_cvt_pk_bf16_f32 v24, v136, v137
    v_cvt_pk_bf16_f32 v25, v138, v139
    v_mov_b64 v[136:137], v[36:37]
    v_mov_b64 v[138:139], v[36:37]
    v_pk_mul_f32 v[152:153], v[152:153], v[44:45] op_sel_hi:[1,0]
    v_pk_mul_f32 v[154:155], v[154:155], v[44:45] op_sel_hi:[1,0]
    v_cvt_pk_bf16_f32 v26, v152, v153
    v_cvt_pk_bf16_f32 v27, v154, v155
    v_mov_b64 v[152:153], v[36:37]
    v_mov_b64 v[154:155], v[36:37]
    v_pk_mul_f32 v[140:141], v[140:141], v[46:47] op_sel_hi:[1,0]
    v_pk_mul_f32 v[142:143], v[142:143], v[46:47] op_sel_hi:[1,0]
    v_cvt_pk_bf16_f32 v28, v140, v141
    v_cvt_pk_bf16_f32 v29, v142, v143
    v_mov_b64 v[140:141], v[38:39]
    v_mov_b64 v[142:143], v[38:39]
    v_pk_mul_f32 v[156:157], v[156:157], v[46:47] op_sel_hi:[1,0]
    v_pk_mul_f32 v[158:159], v[158:159], v[46:47] op_sel_hi:[1,0]
    v_cvt_pk_bf16_f32 v30, v156, v157
    v_cvt_pk_bf16_f32 v31, v158, v159
    v_mov_b64 v[156:157], v[38:39]
    v_mov_b64 v[158:159], v[38:39]
    s_waitcnt vmcnt(0)
    v_cmp_ne_u32 vcc, s27, v49
    s_nop 4
    s_cbranch_vccz L_F3OK
    s_mov_b32 s34, 0
PL_13:
    buffer_load_dword v49, v48, s[16:19], s28 offen sc1
    s_waitcnt vmcnt(0)
    v_xor_b32 v49, s27, v49
    v_cmp_ne_u32 vcc, 0, v49
    s_add_u32 s34, s34, 1
    s_cmp_ge_u32 s34, 16384
    s_cbranch_scc1 PL_13_x
    s_cbranch_vccz PL_13_x
    s_sleep 3
    s_branch PL_13
PL_13_x:
L_F3OK:
    buffer_load_dwordx4 v[64:67], v9, s[16:19], s33 offen offset:0 sc1
    buffer_load_dwordx4 v[68:71], v9, s[16:19], s33 offen offset:1024 sc1
    buffer_load_dwordx4 v[72:75], v9, s[16:19], s33 offen offset:2048 sc1
    buffer_load_dwordx4 v[76:79], v9, s[16:19], s33 offen offset:3072 sc1
    buffer_load_dwordx4 v[80:83], v10, s[16:19], s33 offen offset:0 sc1
    buffer_load_dwordx4 v[84:87], v10, s[16:19], s33 offen offset:1024 sc1
    buffer_load_dwordx4 v[88:91], v10, s[16:19], s33 offen offset:2048 sc1
    buffer_load_dwordx4 v[92:95], v10, s[16:19], s33 offen offset:3072 sc1
    buffer_load_dwordx4 v[96:99], v11, s[16:19], s33 offen offset:0 sc1
    buffer_load_dwordx4 v[100:103], v11, s[16:19], s33 offen offset:1024 sc1
    buffer_load_dwordx4 v[104:107], v11, s[16:19], s33 offen offset:2048 sc1
    buffer_load_dwordx4 v[108:111], v11, s[16:19], s33 offen offset:3072 sc1
    buffer_load_dwordx4 v[112:115], v12, s[16:19], s33 offen offset:0 sc1
    buffer_load_dwordx4 v[116:119], v12, s[16:19], s33 offen offset:1024 sc1
    buffer_load_dwordx4 v[120:123], v12, s[16:19], s33 offen offset:2048 sc1
    buffer_load_dwordx4 v[124:127], v12, s[16:19], s33 offen offset:3072 sc1
    v_mov_b64 v[160:161], 0
    v_mov_b64 v[162:163], 0
    v_mov_b64 v[164:165], 0
    v_mov_b64 v[166:167], 0
    v_mov_b64 v[168:169], 0
    v_mov_b64 v[170:171], 0
    v_mov_b64 v[172:173], 0
    v_mov_b64 v[174:175], 0
    v_mov_b64 v[176:177], 0
    v_mov_b64 v[178:179], 0
    v_mov_b64 v[180:181], 0
    v_mov_b64 v[182:183], 0
    v_mov_b64 v[184:185], 0
    v_mov_b64 v[186:187], 0
    v_mov_b64 v[188:189], 0
    v_mov_b64 v[190:191], 0
    v_mov_b64 v[192:193], 0
    v_mov_b64 v[194:195], 0
    v_mov_b64 v[196:197], 0
    v_mov_b64 v[198:199], 0
    v_mov_b64 v[200:201], 0
    v_mov_b64 v[202:203], 0
    v_mov_b64 v[204:205], 0
    v_mov_b64 v[206:207], 0
    v_mov_b64 v[208:209], 0
    v_mov_b64 v[210:211], 0
    v_mov_b64 v[212:213], 0
    v_mov_b64 v[214:215], 0
    v_mov_b64 v[216:217], 0
    v_mov_b64 v[218:219], 0
    v_mov_b64 v[220:221], 0
    v_mov_b64 v[222:223], 0
    v_mov_b64 v[224:225], 0
    v_mov_b64 v[226:227], 0
    v_mov_b64 v[228:229], 0
    v_mov_b64 v[230:231], 0
    v_mov_b64 v[232:233], 0
    v_mov_b64 v[234:235], 0
    v_mov_b64 v[236:237], 0
    v_mov_b64 v[238:239], 0
    v_mov_b64 v[240:241], 0
    v_mov_b64 v[242:243], 0
    v_mov_b64 v[244:245], 0
    v_mov_b64 v[246:247], 0
    v_mov_b64 v[248:249], 0
    v_mov_b64 v[250:251], 0
    v_mov_b64 v[252:253], 0
    v_mov_b64 v[254:255], 0
    s_waitcnt vmcnt(8)
    s_mov_b32 s5, 0
    s_setprio 0
L_SLOOP:
    s_add_u32 s6, s6, 1
    s_and_b32 s6, s6, 7
    s_lshl_b32 s33, s6, 14
    s_add_u32 s33, s33, s0
    s_waitcnt vmcnt(12)
    ds_read_b128 v[32:35], v13 offset:0
    ds_read_b128 v[36:39], v14 offset:0
    ds_read_b128 v[40:43], v13 offset:2048
    ds_read_b128 v[44:47], v14 offset:2048
    ds_read_b128 v[48:51], v13 offset:4096
    ds_read_b128 v[52:55], v14 offset:4096
    ds_read_b128 v[56:59], v13 offset:6144
    ds_read_b128 v[60:63], v14 offset:6144
    s_lshl_b32 s31, s6, 7
    s_add_u32 s31, s31, s3
    s_add_u32 s32, s31, 131072
    s_mov_b32 m0, s30
    s_waitcnt vmcnt(22)
.p2align 3
    s_waitcnt lgkmcnt(6)
    s_nop 0
    v_mfma_f32_16x16x32_bf16 v[128:131], v[64:67], v[32:35], v[128:131]
    v_mfma_f32_16x16x32_bf16 v[128:131], v[68:71], v[36:39], v[128:131]
    s_waitcnt lgkmcnt(4)
    s_nop 0
    v_mfma_f32_16x16x32_bf16 v[132:135], v[64:67], v[40:43], v[132:135]
    v_mfma_f32_16x16x32_bf16 v[132:135], v[68:71], v[44:47], v[132:135]
    s_waitcnt lgkmcnt(2)
    s_nop 0
    v_mfma_f32_16x16x32_bf16 v[136:139], v[64:67], v[48:51], v[136:139]
    v_mfma_f32_16x16x32_bf16 v[136:139], v[68:71], v[52:55], v[136:139]
    s_waitcnt lgkmcnt(0)
    s_nop 0
    v_mfma_f32_16x16x32_bf16 v[140:143], v[64:67], v[56:59], v[140:143]
    v_mfma_f32_16x16x32_bf16 v[140:143], v[68:71], v[60:63], v[140:143]
    s_waitcnt vmcnt(16)
.p2align 3
    v_mfma_f32_16x16x32_bf16 v[144:147], v[72:75], v[32:35], v[144:147]
    v_mfma_f32_16x16x32_bf16 v[144:147], v[76:79], v[36:39], v[144:147]
    buffer_load_dwordx4 v[64:67], v9, s[16:19], s33 offen offset:0 sc1
    buffer_load_dwordx4 v[68:71], v9, s[16:19], s33 offen offset:1024 sc1
    v_mfma_f32_16x16x32_bf16 v[148:151], v[72:75], v[40:43], v[148:151]
    v_mfma_f32_16x16x32_bf16 v[148:151], v[76:79], v[44:47], v[148:151]
    buffer_load_dwordx4 v5, s[12:15], s31 offen offset:0 lds
    buffer_load_dwordx4 v6, s[12:15], s31 offen offset:1024 lds
    v_mfma_f32_16x16x32_bf16 v[152:155], v[72:75], v[48:51], v[152:155]
    v_mfma_f32_16x16x32_bf16 v[152:155], v[76:79], v[52:55], v[152:155]
    buffer_load_dwordx4 v7, s[12:15], s31 offen offset:2048 lds
    v_mfma_f32_16x16x32_bf16 v[156:159], v[72:75], v[56:59], v[156:159]
    v_mfma_f32_16x16x32_bf16 v[156:159], v[76:79], v[60:63], v[156:159]
    buffer_load_dwordx4 v8, s[12:15], s31 offen offset:3072 lds
    s_waitcnt vmcnt(16)
    s_add_u32 m0, s30, 4096
.p2align 3
    v_mfma_f32_16x16x32_bf16 v[160:163], v[80:83], v[32:35], v[160:163]
    v_mfma_f32_16x16x32_bf16 v[160:163], v[84:87], v[36:39], v[160:163]
    buffer_load_dwordx4 v[72:75], v9, s[16:19], s33 offen offset:2048 sc1
    buffer_load_dwordx4 v[76:79], v9, s[16:19], s33 offen offset:3072 sc1
    v_mfma_f32_16x16x32_bf16 v[164:167], v[80:83], v[40:43], v[164:167]
    v_mfma_f32_16x16x32_bf16 v[164:167], v[84:87], v[44:47], v[164:167]
    buffer_load_dwordx4 v5, s[12:15], s32 offen offset:0 lds
    buffer_load_dwordx4 v6, s[12:15], s32 offen offset:1024 lds
    v_mfma_f32_16x16x32_bf16 v[168:171], v[80:83], v[48:51], v[168:171]
    v_mfma_f32_16x16x32_bf16 v[168:171], v[84:87], v[52:55], v[168:171]
    buffer_load_dwordx4 v7, s[12:15], s32 offen offset:2048 lds
    v_mfma_f32_16x16x32_bf16 v[172:175], v[80:83], v[56:59], v[172:175]
    v_mfma_f32_16x16x32_bf16 v[172:175], v[84:87], v[60:63], v[172:175]
    buffer_load_dwordx4 v8, s[12:15], s32 offen offset:3072 lds
    s_waitcnt vmcnt(20)
.p2align 3
    v_mfma_f32_16x16x32_bf16 v[176:179], v[88:91], v[32:35], v[176:179]
    v_mfma_f32_16x16x32_bf16 v[176:179], v[92:95], v[36:39], v[176:179]
    buffer_load_dwordx4 v[80:83], v10, s[16:19], s33 offen offset:0 sc1
    v_mfma_f32_16x16x32_bf16 v[180:183], v[88:91], v[40:43], v[180:183]
    v_mfma_f32_16x16x32_bf16 v[180:183], v[92:95], v[44:47], v[180:183]
    buffer_load_dwordx4 v[84:87], v10, s[16:19], s33 offen offset:1024 sc1
    v_mfma_f32_16x16x32_bf16 v[184:187], v[88:91], v[48:51], v[184:187]
    v_mfma_f32_16x16x32_bf16 v[184:187], v[92:95], v[52:55], v[184:187]
    v_mfma_f32_16x16x32_bf16 v[188:191], v[88:91], v[56:59], v[188:191]
    v_mfma_f32_16x16x32_bf16 v[188:191], v[92:95], v[60:63], v[188:191]
    s_waitcnt vmcnt(20)
.p2align 3
    v_mfma_f32_16x16x32_bf16 v[192:195], v[96:99], v[32:35], v[192:195]
    v_mfma_f32_16x16x32_bf16 v[192:195], v[100:103], v[36:39], v[192:195]
    buffer_load_dwordx4 v[88:91], v10, s[16:19], s33 offen offset:2048 sc1
    v_mfma_f32_16x16x32_bf16 v[196:199], v[96:99], v[40:43], v[196:199]
    v_mfma_f32_16x16x32_bf16 v[196:199], v[100:103], v[44:47], v[196:199]
    buffer_load_dwordx4 v[92:95], v10, s[16:19], s33 offen offset:3072 sc1
    v_mfma_f32_16x16x32_bf16 v[200:203], v[96:99], v[48:51], v[200:203]
    v_mfma_f32_16x16x32_bf16 v[200:203], v[100:103], v[52:55], v[200:203]
    v_mfma_f32_16x16x32_bf16 v[204:207], v[96:99], v[56:59], v[204:207]
    v_mfma_f32_16x16x32_bf16 v[204:207], v[100:103], v[60:63], v[204:207]
    s_waitcnt vmcnt(20)
.p2align 3
    v_mfma_f32_16x16x32_bf16 v[208:211], v[104:107], v[32:35], v[208:211]
    v_mfma_f32_16x16x32_bf16 v[208:211], v[108:111], v[36:39], v[208:211]
    buffer_load_dwordx4 v[96:99], v11, s[16:19], s33 offen offset:0 sc1
    v_mfma_f32_16x16x32_bf16 v[212:215], v[104:107], v[40:43], v[212:215]
    v_mfma_f32_16x16x32_bf16 v[212:215], v[108:111], v[44:47], v[212:215]
    buffer_load_dwordx4 v[100:103], v11, s[16:19], s33 offen offset:1024 sc1
    v_mfma_f32_16x16x32_bf16 v[216:219], v[104:107], v[48:51], v[216:219]
    v_mfma_f32_16x16x32_bf16 v[216:219], v[108:111], v[52:55], v[216:219]
    v_mfma_f32_16x16x32_bf16 v[220:223], v[104:107], v[56:59], v[220:223]
    v_mfma_f32_16x16x32_bf16 v[220:223], v[108:111], v[60:63], v[220:223]
    s_waitcnt vmcnt(20)
.p2align 3
    v_mfma_f32_16x16x32_bf16 v[224:227], v[112:115], v[32:35], v[224:227]
    v_mfma_f32_16x16x32_bf16 v[224:227], v[116:119], v[36:39], v[224:227]
    buffer_load_dwordx4 v[104:107], v11, s[16:19], s33 offen offset:2048 sc1
    v_mfma_f32_16x16x32_bf16 v[228:231], v[112:115], v[40:43], v[228:231]
    v_mfma_f32_16x16x32_bf16 v[228:231], v[116:119], v[44:47], v[228:231]
    buffer_load_dwordx4 v[108:111], v11, s[16:19], s33 offen offset:3072 sc1
    v_mfma_f32_16x16x32_bf16 v[232:235], v[112:115], v[48:51], v[232:235]
    v_mfma_f32_16x16x32_bf16 v[232:235], v[116:119], v[52:55], v[232:235]
    v_mfma_f32_16x16x32_bf16 v[236:239], v[112:115], v[56:59], v[236:239]
    v_mfma_f32_16x16x32_bf16 v[236:239], v[116:119], v[60:63], v[236:239]
    s_waitcnt vmcnt(20)
.p2align 3
    v_mfma_f32_16x16x32_bf16 v[240:243], v[120:123], v[32:35], v[240:243]
    v_mfma_f32_16x16x32_bf16 v[240:243], v[124:127], v[36:39], v[240:243]
    buffer_load_dwordx4 v[112:115], v12, s[16:19], s33 offen offset:0 sc1
    v_mfma_f32_16x16x32_bf16 v[244:247], v[120:123], v[40:43], v[244:247]
    v_mfma_f32_16x16x32_bf16 v[244:247], v[124:127], v[44:47], v[244:247]
    buffer_load_dwordx4 v[116:119], v12, s[16:19], s33 offen offset:1024 sc1
    v_mfma_f32_16x16x32_bf16 v[248:251], v[120:123], v[48:51], v[248:251]
    v_mfma_f32_16x16x32_bf16 v[248:251], v[124:127], v[52:55], v[248:251]
    v_mfma_f32_16x16x32_bf16 v[252:255], v[120:123], v[56:59], v[252:255]
    v_mfma_f32_16x16x32_bf16 v[252:255], v[124:127], v[60:63], v[252:255]
    buffer_load_dwordx4 v[120:123], v12, s[16:19], s33 offen offset:2048 sc1
    buffer_load_dwordx4 v[124:127], v12, s[16:19], s33 offen offset:3072 sc1
    s_add_u32 s5, s5, 1
    s_cmp_lt_u32 s5, 7
    s_cbranch_scc1 L_SLOOP
    s_setprio 2
    s_waitcnt vmcnt(12)
    ds_read_b128 v[32:35], v13 offset:0
    ds_read_b128 v[36:39], v14 offset:0
    ds_read_b128 v[40:43], v13 offset:2048
    ds_read_b128 v[44:47], v14 offset:2048
    ds_read_b128 v[48:51], v13 offset:4096
    ds_read_b128 v[52:55], v14 offset:4096
    ds_read_b128 v[56:59], v13 offset:6144
    ds_read_b128 v[60:63], v14 offset:6144
    v_and_b32 v8, 15, v1
    v_lshlrev_b32 v8, 7, v8
    s_lshl_b32 s28, s26, 11
    s_add_u32 s28, s28, 0x16bc000
    buffer_load_dword v9, v8, s[16:19], s28 offen sc1
    v_add_u32 v5, s30, v4
    s_lshl_b32 s32, s7, 14
    s_add_u32 s32, s32, 32768
    v_add_u32 v6, s32, v4
    s_sub_u32 s32, s7, 1
    s_and_b32 s32, s32, 3
    s_lshl_b32 s32, s32, 13
    s_add_u32 s32, s32, 131072
    v_add_u32 v10, s32, v4
    s_sub_u32 s32, s7, 2
    s_and_b32 s32, s32, 3
    s_lshl_b32 s32, s32, 14
    s_add_u32 s32, s32, 32768
    v_add_u32 v11, s32, v4
    s_sub_u32 s32, s7, 3
    s_and_b32 s32, s32, 3
    s_lshl_b32 s32, s32, 14
    s_add_u32 s32, s32, 40960
    v_add_u32 v12, s32, v4
    s_mul_i32 s29, s26, 44
    s_mul_i32 s32, s7, 7
    s_add_u32 s29, s29, s32
    s_lshl_b32 s29, s29, 12
    s_add_u32 s29, s29, 0x1400000
    s_waitcnt lgkmcnt(0)
    s_setprio 0
    s_waitcnt vmcnt(11)
.p2align 3
    v_mfma_f32_16x16x32_bf16 v[160:163], v[80:83], v[32:35], v[160:163]
    v_mfma_f32_16x16x32_bf16 v[160:163], v[84:87], v[36:39], v[160:163]
    v_mfma_f32_16x16x32_bf16 v[164:167], v[80:83], v[40:43], v[164:167]
    v_mfma_f32_16x16x32_bf16 v[164:167], v[84:87], v[44:47], v[164:167]
    v_mfma_f32_16x16x32_bf16 v[168:171], v[80:83], v[48:51], v[168:171]
    v_mfma_f32_16x16x32_bf16 v[168:171], v[84:87], v[52:55], v[168:171]
    v_mfma_f32_16x16x32_bf16 v[172:175], v[80:83], v[56:59], v[172:175]
    v_mfma_f32_16x16x32_bf16 v[172:175], v[84:87], v[60:63], v[172:175]
    s_waitcnt vmcnt(9)
.p2align 3
    v_mfma_f32_16x16x32_bf16 v[176:179], v[88:91], v[32:35], v[176:179]
    v_mfma_f32_16x16x32_bf16 v[176:179], v[92:95], v[36:39], v[176:179]
    v_mfma_f32_16x16x32_bf16 v[180:183], v[88:91], v[40:43], v[180:183]
    v_mfma_f32_16x16x32_bf16 v[180:183], v[92:95], v[44:47], v[180:183]
    v_mfma_f32_16x16x32_bf16 v[184:187], v[88:91], v[48:51], v[184:187]
    v_mfma_f32_16x16x32_bf16 v[184:187], v[92:95], v[52:55], v[184:187]
    v_mfma_f32_16x16x32_bf16 v[188:191], v[88:91], v[56:59], v[188:191]
    v_mfma_f32_16x16x32_bf16 v[188:191], v[92:95], v[60:63], v[188:191]
    s_waitcnt vmcnt(7)
.p2align 3
    v_mfma_f32_16x16x32_bf16 v[192:195], v[96:99], v[32:35], v[192:195]
    v_mfma_f32_16x16x32_bf16 v[192:195], v[100:103], v[36:39], v[192:195]
    ds_write_b128 v5, v[160:163] offset:0
    v_mfma_f32_16x16x32_bf16 v[196:199], v[96:99], v[40:43], v[196:199]
    v_mfma_f32_16x16x32_bf16 v[196:199], v[100:103], v[44:47], v[196:199]
    ds_write_b128 v5, v[164:167] offset:1024
    v_mfma_f32_16x16x32_bf16 v[200:203], v[96:99], v[48:51], v[200:203]
    v_mfma_f32_16x16x32_bf16 v[200:203], v[100:103], v[52:55], v[200:203]
    ds_write_b128 v5, v[168:171] offset:2048
    v_mfma_f32_16x16x32_bf16 v[204:207], v[96:99], v[56:59], v[204:207]
    v_mfma_f32_16x16x32_bf16 v[204:207], v[100:103], v[60:63], v[204:207]
    ds_write_b128 v5, v[172:175] offset:3072
    s_waitcnt vmcnt(5)
.p2align 3
    v_mfma_f32_16x16x32_bf16 v[208:211], v[104:107], v[32:35], v[208:211]
    v_mfma_f32_16x16x32_bf16 v[208:211], v[108:111], v[36:39], v[208:211]
    ds_write_b128 v5, v[176:179] offset:4096
    v_mfma_f32_16x16x32_bf16 v[212:215], v[104:107], v[40:43], v[212:215]
    v_mfma_f32_16x16x32_bf16 v[212:215], v[108:111], v[44:47], v[212:215]
    ds_write_b128 v5, v[180:183] offset:5120
    v_mfma_f32_16x16x32_bf16 v[216:219], v[104:107], v[48:51], v[216:219]
    v_mfma_f32_16x16x32_bf16 v[216:219], v[108:111], v[52:55], v[216:219]
    ds_write_b128 v5, v[184:187] offset:6144
    v_mfma_f32_16x16x32_bf16 v[220:223], v[104:107], v[56:59], v[220:223]
    v_mfma_f32_16x16x32_bf16 v[220:223], v[108:111], v[60:63], v[220:223]
    ds_write_b128 v5, v[188:191] offset:7168
    s_waitcnt lgkmcnt(0)
    s_setprio 2
    s_waitcnt vmcnt(0)
    v_cmp_ne_u32 vcc, s27, v9
    s_mov_b32 s34, 0
LW_14:
    ds_read_b32 v7, v2 offset:56
    s_waitcnt lgkmcnt(0)
    v_readfirstlane_b32 s35, v7
    s_add_u32 s34, s34, 1
    s_cmp_ge_u32 s34, 131072
    s_cbranch_scc1 LW_14_x
    s_cmp_lt_u32 s35, 16843009
    s_cbranch_scc1 LW_14
LW_14_x:
    s_cbranch_vccz L_F6OK
    s_mov_b32 s34, 0
PL_15:
    buffer_load_dword v9, v8, s[16:19], s28 offen sc1
    s_waitcnt vmcnt(0)
    v_xor_b32 v9, s27, v9
    v_cmp_ne_u32 vcc, 0, v9
    s_add_u32 s34, s34, 1
    s_cmp_ge_u32 s34, 16384
    s_cbranch_scc1 PL_15_x
    s_cbranch_vccz PL_15_x
    s_sleep 4
    s_branch PL_15
PL_15_x:
L_F6OK:
    s_setprio 0
.p2align 3
    v_mfma_f32_16x16x32_bf16 v[224:227], v[112:115], v[32:35], v[224:227]
    v_mfma_f32_16x16x32_bf16 v[224:227], v[116:119], v[36:39], v[224:227]
    ds_write_b128 v6, v[192:195] offset:0
    buffer_load_dwordx4 v[96:99], v4, s[16:19], s29 offen offset:0 sc1
    buffer_load_dwordx4 v[100:103], v4, s[16:19], s29 offen offset:1024 sc1
    buffer_load_dwordx4 v[104:107], v4, s[16:19], s29 offen offset:2048 sc1
    buffer_load_dwordx4 v[108:111], v4, s[16:19], s29 offen offset:3072 sc1
    s_add_u32 s29, s29, 4096
    v_mfma_f32_16x16x32_bf16 v[228:231], v[112:115], v[40:43], v[228:231]
    v_mfma_f32_16x16x32_bf16 v[228:231], v[116:119], v[44:47], v[228:231]
    ds_write_b128 v6, v[196:199] offset:1024
    v_mfma_f32_16x16x32_bf16 v[232:235], v[112:115], v[48:51], v[232:235]
    v_mfma_f32_16x16x32_bf16 v[232:235], v[116:119], v[52:55], v[232:235]
    ds_write_b128 v6, v[200:203] offset:2048
    buffer_load_dwordx4 v[160:163], v4, s[16:19], s29 offen offset:0 sc1
    buffer_load_dwordx4 v[164:167], v4, s[16:19], s29 offen offset:1024 sc1
    buffer_load_dwordx4 v[168:171], v4, s[16:19], s29 offen offset:2048 sc1
    buffer_load_dwordx4 v[172:175], v4, s[16:19], s29 offen offset:3072 sc1
    s_add_u32 s29, s29, 4096
    v_mfma_f32_16x16x32_bf16 v[236:239], v[112:115], v[56:59], v[236:239]
    v_mfma_f32_16x16x32_bf16 v[236:239], v[116:119], v[60:63], v[236:239]
    ds_write_b128 v6, v[204:207] offset:3072
.p2align 3
    v_mfma_f32_16x16x32_bf16 v[240:243], v[120:123], v[32:35], v[240:243]
    v_mfma_f32_16x16x32_bf16 v[240:243], v[124:127], v[36:39], v[240:243]
    ds_write_b128 v6, v[208:211] offset:4096
    buffer_load_dwordx4 v[176:179], v4, s[16:19], s29 offen offset:0 sc1
    buffer_load_dwordx4 v[180:183], v4, s[16:19], s29 offen offset:1024 sc1
    buffer_load_dwordx4 v[184:187], v4, s[16:19], s29 offen offset:2048 sc1
    buffer_load_dwordx4 v[188:191], v4, s[16:19], s29 offen offset:3072 sc1
    s_add_u32 s29, s29, 4096
    v_mfma_f32_16x16x32_bf16 v[244:247], v[120:123], v[40:43], v[244:247]
    v_mfma_f32_16x16x32_bf16 v[244:247], v[124:127], v[44:47], v[244:247]
    ds_write_b128 v6, v[212:215] offset:5120
    v_mfma_f32_16x16x32_bf16 v[248:251], v[120:123], v[48:51], v[248:251]
    v_mfma_f32_16x16x32_bf16 v[248:251], v[124:127], v[52:55], v[248:251]
    ds_write_b128 v6, v[216:219] offset:6144
    v_mfma_f32_16x16x32_bf16 v[252:255], v[120:123], v[56:59], v[252:255]
    v_mfma_f32_16x16x32_bf16 v[252:255], v[124:127], v[60:63], v[252:255]
    ds_write_b128 v6, v[220:223] offset:7168
    s_waitcnt lgkmcnt(0)
.p2align 3
    v_mfma_f32_16x16x32_bf16 v[128:131], v[64:67], v[32:35], v[128:131]
    v_mfma_f32_16x16x32_bf16 v[128:131], v[68:71], v[36:39], v[128:131]
    ds_write_b128 v6, v[224:227] offset:8192
    buffer_load_dwordx4 v[112:115], v4, s[16:19], s29 offen offset:0 sc1
    buffer_load_dwordx4 v[116:119], v4, s[16:19], s29 offen offset:1024 sc1
    buffer_load_dwordx4 v[120:123], v4, s[16:19], s29 offen offset:2048 sc1
    buffer_load_dwordx4 v[124:127], v4, s[16:19], s29 offen offset:3072 sc1
    s_add_u32 s29, s29, 4096
    v_mfma_f32_16x16x32_bf16 v[132:135], v[64:67], v[40:43], v[132:135]
    v_mfma_f32_16x16x32_bf16 v[132:135], v[68:71], v[44:47], v[132:135]
    ds_write_b128 v6, v[228:231] offset:9216
    v_mfma_f32_16x16x32_bf16 v[136:139], v[64:67], v[48:51], v[136:139]
    v_mfma_f32_16x16x32_bf16 v[136:139], v[68:71], v[52:55], v[136:139]
    ds_write_b128 v6, v[232:235] offset:10240
    buffer_load_dwordx4 v[192:195], v4, s[16:19], s29 offen offset:0 sc1
    buffer_load_dwordx4 v[196:199], v4, s[16:19], s29 offen offset:1024 sc1
    buffer_load_dwordx4 v[200:203], v4, s[16:19], s29 offen offset:2048 sc1
    buffer_load_dwordx4 v[204:207], v4, s[16:19], s29 offen offset:3072 sc1
    s_add_u32 s29, s29, 4096
    v_mfma_f32_16x16x32_bf16 v[140:143], v[64:67], v[56:59], v[140:143]
    v_mfma_f32_16x16x32_bf16 v[140:143], v[68:71], v[60:63], v[140:143]
    ds_write_b128 v6, v[236:239] offset:11264
.p2align 3
    v_mfma_f32_16x16x32_bf16 v[144:147], v[72:75], v[32:35], v[144:147]
    v_mfma_f32_16x16x32_bf16 v[144:147], v[76:79], v[36:39], v[144:147]
    ds_write_b128 v6, v[240:243] offset:12288
    buffer_load_dwordx4 v[208:211], v4, s[16:19], s29 offen offset:0 sc1
    buffer_load_dwordx4 v[212:215], v4, s[16:19], s29 offen offset:1024 sc1
    buffer_load_dwordx4 v[216:219], v4, s[16:19], s29 offen offset:2048 sc1
    buffer_load_dwordx4 v[220:223], v4, s[16:19], s29 offen offset:3072 sc1
    s_add_u32 s29, s29, 4096
    v_mfma_f32_16x16x32_bf16 v[148:151], v[72:75], v[40:43], v[148:151]
    v_mfma_f32_16x16x32_bf16 v[148:151], v[76:79], v[44:47], v[148:151]
    ds_write_b128 v6, v[244:247] offset:13312
    v_mfma_f32_16x16x32_bf16 v[152:155], v[72:75], v[48:51], v[152:155]
    v_mfma_f32_16x16x32_bf16 v[152:155], v[76:79], v[52:55], v[152:155]
    ds_write_b128 v6, v[248:251] offset:14336
    v_mfma_f32_16x16x32_bf16 v[156:159], v[72:75], v[56:59], v[156:159]
    v_mfma_f32_16x16x32_bf16 v[156:159], v[76:79], v[60:63], v[156:159]
    ds_write_b128 v6, v[252:255] offset:15360
    s_waitcnt lgkmcnt(0)
    s_setprio 2
    s_mov_b64 exec, 1
    ds_add_u32 v2, v3 offset:16
    s_mov_b64 exec, -1
    buffer_load_dwordx4 v[224:227], v4, s[16:19], s29 offen offset:0 sc1
    buffer_load_dwordx4 v[228:231], v4, s[16:19], s29 offen offset:1024 sc1
    buffer_load_dwordx4 v[232:235], v4, s[16:19], s29 offen offset:2048 sc1
    buffer_load_dwordx4 v[236:239], v4, s[16:19], s29 offen offset:3072 sc1
    s_add_u32 s29, s29, 4096
    s_mov_b32 s34, 0
LW_16:
    ds_read_b32 v7, v2 offset:16
    s_waitcnt lgkmcnt(0)
    v_readfirstlane_b32 s35, v7
    s_add_u32 s34, s34, 1
    s_cmp_ge_u32 s34, 131072
    s_cbranch_scc1 LW_16_x
    s_cmp_lt_u32 s35, 12
    s_cbranch_scc1 LW_16
LW_16_x:
    ds_read_b128 v[32:35], v11 offset:0
    ds_read_b128 v[36:39], v11 offset:1024
    ds_read_b128 v[40:43], v11 offset:2048
    ds_read_b128 v[44:47], v11 offset:3072
    ds_read_b128 v[48:51], v11 offset:4096
    ds_read_b128 v[52:55], v11 offset:5120
    ds_read_b128 v[56:59], v11 offset:6144
    ds_read_b128 v[60:63], v11 offset:7168
    s_waitcnt lgkmcnt(4)
    ds_read_b128 v[64:67], v12 offset:0
    ds_read_b128 v[68:71], v12 offset:1024
    ds_read_b128 v[72:75], v12 offset:2048
    ds_read_b128 v[76:79], v12 offset:3072
    ds_read_b128 v[80:83], v12 offset:4096
    ds_read_b128 v[84:87], v12 offset:5120
    ds_read_b128 v[88:91], v12 offset:6144
    ds_read_b128 v[92:95], v12 offset:7168
    s_waitcnt lgkmcnt(8)
    v_pk_add_f32 v[128:129], v[128:129], v[32:33]
    v_pk_add_f32 v[130:131], v[130:131], v[34:35]
    v_pk_add_f32 v[132:133], v[132:133], v[36:37]
    v_pk_add_f32 v[134:135], v[134:135], v[38:39]
    v_pk_add_f32 v[136:137], v[136:137], v[40:41]
    v_pk_add_f32 v[138:139], v[138:139], v[42:43]
    v_pk_add_f32 v[140:141], v[140:141], v[44:45]
    v_pk_add_f32 v[142:143], v[142:143], v[46:47]
    v_pk_add_f32 v[144:145], v[144:145], v[48:49]
    v_pk_add_f32 v[146:147], v[146:147], v[50:51]
    v_pk_add_f32 v[148:149], v[148:149], v[52:53]
    v_pk_add_f32 v[150:151], v[150:151], v[54:55]
    v_pk_add_f32 v[152:153], v[152:153], v[56:57]
    v_pk_add_f32 v[154:155], v[154:155], v[58:59]
    v_pk_add_f32 v[156:157], v[156:157], v[60:61]
    v_pk_add_f32 v[158:159], v[158:159], v[62:63]
    s_waitcnt lgkmcnt(4)
    ds_read_b128 v[32:35], v10 offset:0
    ds_read_b128 v[36:39], v10 offset:1024
    ds_read_b128 v[40:43], v10 offset:2048
    ds_read_b128 v[44:47], v10 offset:3072
    ds_read_b128 v[48:51], v10 offset:4096
    ds_read_b128 v[52:55], v10 offset:5120
    ds_read_b128 v[56:59], v10 offset:6144
    ds_read_b128 v[60:63], v10 offset:7168
    s_waitcnt lgkmcnt(8)
    v_pk_add_f32 v[128:129], v[128:129], v[64:65]
    v_pk_add_f32 v[130:131], v[130:131], v[66:67]
    v_pk_add_f32 v[132:133], v[132:133], v[68:69]
    v_pk_add_f32 v[134:135], v[134:135], v[70:71]
    v_pk_add_f32 v[136:137], v[136:137], v[72:73]
    v_pk_add_f32 v[138:139], v[138:139], v[74:75]
    v_pk_add_f32 v[140:141], v[140:141], v[76:77]
    v_pk_add_f32 v[142:143], v[142:143], v[78:79]
    v_pk_add_f32 v[144:145], v[144:145], v[80:81]
    v_pk_add_f32 v[146:147], v[146:147], v[82:83]
    v_pk_add_f32 v[148:149], v[148:149], v[84:85]
    v_pk_add_f32 v[150:151], v[150:151], v[86:87]
    v_pk_add_f32 v[152:153], v[152:153], v[88:89]
    v_pk_add_f32 v[154:155], v[154:155], v[90:91]
    v_pk_add_f32 v[156:157], v[156:157], v[92:93]
    v_pk_add_f32 v[158:159], v[158:159], v[94:95]
    s_waitcnt lgkmcnt(0)
    s_mov_b64 exec, 1
    ds_add_u32 v2, v3 offset:16
    s_mov_b64 exec, -1
    v_pk_add_f32 v[128:129], v[128:129], v[32:33]
    v_pk_add_f32 v[130:131], v[130:131], v[34:35]
    v_pk_add_f32 v[132:133], v[132:133], v[36:37]
    v_pk_add_f32 v[134:135], v[134:135], v[38:39]
    v_pk_add_f32 v[136:137], v[136:137], v[40:41]
    v_pk_add_f32 v[138:139], v[138:139], v[42:43]
    v_pk_add_f32 v[140:141], v[140:141], v[44:45]
    v_pk_add_f32 v[142:143], v[142:143], v[46:47]
    v_pk_add_f32 v[144:145], v[144:145], v[48:49]
    v_pk_add_f32 v[146:147], v[146:147], v[50:51]
    v_pk_add_f32 v[148:149], v[148:149], v[52:53]
    v_pk_add_f32 v[150:151], v[150:151], v[54:55]
    v_pk_add_f32 v[152:153], v[152:153], v[56:57]
    v_pk_add_f32 v[154:155], v[154:155], v[58:59]
    v_pk_add_f32 v[156:157], v[156:157], v[60:61]
    v_pk_add_f32 v[158:159], v[158:159], v[62:63]
    v_and_b32 v5, 15, v1
    v_lshlrev_b32 v5, 4, v5
    v_bfe_u32 v6, v1, 4, 1
    v_lshl_add_u32 v5, v6, 9, v5
    v_lshrrev_b32 v6, 5, v1
    v_lshl_add_u32 v5, v6, 8, v5
    s_mul_i32 s31, s25, 44
    s_lshl_b32 s32, s4, 2
    s_add_u32 s32, s32, s7
    s_add_u32 s31, s31, s32
    s_lshl_b32 s31, s31, 12
    s_add_u32 s31, s31, 0xe00000
    v_lshlrev_b32 v32, 16, v16
    v_and_b32 v33, 0xffff0000, v16
    v_lshlrev_b32 v34, 16, v17
    v_and_b32 v35, 0xffff0000, v17
    v_lshlrev_b32 v36, 16, v18
    v_and_b32 v37, 0xffff0000, v18
    v_lshlrev_b32 v38, 16, v19
    v_and_b32 v39, 0xffff0000, v19
    v_pk_mul_f32 v[128:129], v[128:129], v[32:33]
    v_pk_mul_f32 v[130:131], v[130:131], v[34:35]
    v_pk_mul_f32 v[144:145], v[144:145], v[36:37]
    v_pk_mul_f32 v[146:147], v[146:147], v[38:39]
    v_cvt_pk_bf16_f32 v48, v128, v129
    v_cvt_pk_bf16_f32 v49, v130, v131
    v_cvt_pk_bf16_f32 v50, v144, v145
    v_cvt_pk_bf16_f32 v51, v146, v147
    s_nop 1
    v_permlane16_swap_b32 v48, v50
    v_permlane16_swap_b32 v49, v51
    buffer_store_dwordx4 v[48:51], v5, s[16:19], s31 offen offset:0 sc1
    v_lshlrev_b32 v32, 16, v20
    v_and_b32 v33, 0xffff0000, v20
    v_lshlrev_b32 v34, 16, v21
    v_and_b32 v35, 0xffff0000, v21
    v_lshlrev_b32 v36, 16, v22
    v_and_b32 v37, 0xffff0000, v22
    v_lshlrev_b32 v38, 16, v23
    v_and_b32 v39, 0xffff0000, v23
    v_pk_mul_f32 v[132:133], v[132:133], v[32:33]
    v_pk_mul_f32 v[134:135], v[134:135], v[34:35]
    v_pk_mul_f32 v[148:149], v[148:149], v[36:37]
    v_pk_mul_f32 v[150:151], v[150:151], v[38:39]
    v_cvt_pk_bf16_f32 v52, v132, v133
    v_cvt_pk_bf16_f32 v53, v134, v135
    v_cvt_pk_bf16_f32 v54, v148, v149
    v_cvt_pk_bf16_f32 v55, v150, v151
    s_nop 1
    v_permlane16_swap_b32 v52, v54
    v_permlane16_swap_b32 v53, v55
    buffer_store_dwordx4 v[52:55], v5, s[16:19], s31 offen offset:1024 sc1
    v_lshlrev_b32 v32, 16, v24
    v_and_b32 v33, 0xffff0000, v24
    v_lshlrev_b32 v34, 16, v25
    v_and_b32 v35, 0xffff0000, v25
    v_lshlrev_b32 v36, 16, v26
    v_and_b32 v37, 0xffff0000, v26
    v_lshlrev_b32 v38, 16, v27
    v_and_b32 v39, 0xffff0000, v27
    v_pk_mul_f32 v[136:137], v[136:137], v[32:33]
    v_pk_mul_f32 v[138:139], v[138:139], v[34:35]
    v_pk_mul_f32 v[152:153], v[152:153], v[36:37]
    v_pk_mul_f32 v[154:155], v[154:155], v[38:39]
    v_cvt_pk_bf16_f32 v56, v136, v137
    v_cvt_pk_bf16_f32 v57, v138, v139
    v_cvt_pk_bf16_f32 v58, v152, v153
    v_cvt_pk_bf16_f32 v59, v154, v155
    s_nop 1
    v_permlane16_swap_b32 v56, v58
    v_permlane16_swap_b32 v57, v59
    buffer_store_dwordx4 v[56:59], v5, s[16:19], s31 offen offset:2048 sc1
    v_lshlrev_b32 v32, 16, v28
    v_and_b32 v33, 0xffff0000, v28
    v_lshlrev_b32 v34, 16, v29
    v_and_b32 v35, 0xffff0000, v29
    v_lshlrev_b32 v36, 16, v30
    v_and_b32 v37, 0xffff0000, v30
    v_lshlrev_b32 v38, 16, v31
    v_and_b32 v39, 0xffff0000, v31
    v_pk_mul_f32 v[140:141], v[140:141], v[32:33]
    v_pk_mul_f32 v[142:143], v[142:143], v[34:35]
    v_pk_mul_f32 v[156:157], v[156:157], v[36:37]
    v_pk_mul_f32 v[158:159], v[158:159], v[38:39]
    v_cvt_pk_bf16_f32 v60, v140, v141
    v_cvt_pk_bf16_f32 v61, v142, v143
    v_cvt_pk_bf16_f32 v62, v156, v157
    v_cvt_pk_bf16_f32 v63, v158, v159
    s_nop 1
    v_permlane16_swap_b32 v60, v62
    v_permlane16_swap_b32 v61, v63
    buffer_store_dwordx4 v[60:63], v5, s[16:19], s31 offen offset:3072 sc1
    s_lshl_b32 s31, s25, 12
    s_lshl_b32 s32, s32, 7
    s_add_u32 s31, s31, s32
    s_add_u32 s31, s31, 0x16c0000
    s_mov_b32 s34, 0
LW_17:
    ds_read_b32 v7, v2 offset:16
    s_waitcnt lgkmcnt(0)
    v_readfirstlane_b32 s35, v7
    s_add_u32 s34, s34, 1
    s_cmp_ge_u32 s34, 131072
    s_cbranch_scc1 LW_17_x
    s_cmp_lt_u32 s35, 16
    s_cbranch_scc1 LW_17
LW_17_x:
    s_waitcnt vmcnt(0)
    v_mov_b32 v6, s27
    s_mov_b64 exec, 1
    buffer_store_dword v6, v2, s[16:19], s31 offen sc1
    s_mov_b64 exec, -1
    s_mul_i32 s29, s26, 44
    s_lshl_b32 s32, s7, 1
    s_add_u32 s32, s32, 36
    s_add_u32 s29, s29, s32
    s_lshl_b32 s29, s29, 12
    s_add_u32 s29, s29, 0x1400000
    s_lshl_b32 s33, s7, 14
    s_add_u32 s33, s33, 32768
    s_add_u32 m0, s33, 0
    s_nop 0
    buffer_load_dwordx4 v4, s[16:19], s29 offen offset:0 sc1 lds
    buffer_load_dwordx4 v4, s[16:19], s29 offen offset:1024 sc1 lds
    buffer_load_dwordx4 v4, s[16:19], s29 offen offset:2048 sc1 lds
    buffer_load_dwordx4 v4, s[16:19], s29 offen offset:3072 sc1 lds
    s_add_u32 s29, s29, 4096
    s_add_u32 m0, s33, 4096
    s_nop 0
    buffer_load_dwordx4 v4, s[16:19], s29 offen offset:0 sc1 lds
    buffer_load_dwordx4 v4, s[16:19], s29 offen offset:1024 sc1 lds
    buffer_load_dwordx4 v4, s[16:19], s29 offen offset:2048 sc1 lds
    buffer_load_dwordx4 v4, s[16:19], s29 offen offset:3072 sc1 lds
    s_sub_u32 s29, s29, 36864
    s_add_u32 m0, s33, 8192
    s_nop 0
    buffer_load_dwordx4 v4, s[16:19], s29 offen offset:0 sc1 lds
    buffer_load_dwordx4 v4, s[16:19], s29 offen offset:1024 sc1 lds
    buffer_load_dwordx4 v4, s[16:19], s29 offen offset:2048 sc1 lds
    buffer_load_dwordx4 v4, s[16:19], s29 offen offset:3072 sc1 lds
    s_add_u32 s29, s29, 4096
    s_add_u32 m0, s33, 12288
    s_nop 0
    buffer_load_dwordx4 v4, s[16:19], s29 offen offset:0 sc1 lds
    buffer_load_dwordx4 v4, s[16:19], s29 offen offset:1024 sc1 lds
    buffer_load_dwordx4 v4, s[16:19], s29 offen offset:2048 sc1 lds
    buffer_load_dwordx4 v4, s[16:19], s29 offen offset:3072 sc1 lds
    s_add_u32 s29, s29, 4096
    v_add_u32 v23, s33, v4
    s_branch L_OUT
L_G7:
    s_sub_u32 s32, s30, 32768
    s_and_b32 s3, s2, 7
    v_lshrrev_b32 v16, 4, v1
    v_bfe_u32 v17, v1, 2, 2
    v_lshl_add_u32 v16, v16, 3, v17
    v_lshlrev_b32 v16, 7, v16
    v_bfe_u32 v17, v1, 3, 2
    v_lshl_add_u32 v16, v17, 5, v16
    v_and_b32 v17, 3, v1
    v_lshl_add_u32 v16, v17, 3, v16
    v_add_u32 v9, s32, v16
    v_xor_b32 v10, 32, v9
    v_xor_b32 v11, 64, v9
    v_xor_b32 v12, 96, v9
    s_cmp_lg_u32 s7, 0
    s_cbranch_scc1 L_G7N
    s_mov_b32 s12, s52
    s_mov_b32 s13, s53
    s_mov_b32 s14, 0x400
    s_mov_b32 s15, 0x20000
    v_lshrrev_b32 v16, 4, v1
    v_lshlrev_b32 v16, 4, v16
    buffer_load_dwordx4 v[64:67], v16, s[12:15], 0 offen offset:0
    buffer_load_dwordx4 v[68:71], v16, s[12:15], 0 offen offset:64
    buffer_load_dwordx4 v[72:75], v16, s[12:15], 0 offen offset:128
    buffer_load_dwordx4 v[76:79], v16, s[12:15], 0 offen offset:192
    buffer_load_dwordx4 v[80:83], v16, s[12:15], 0 offen offset:256
    buffer_load_dwordx4 v[84:87], v16, s[12:15], 0 offen offset:320
    buffer_load_dwordx4 v[88:91], v16, s[12:15], 0 offen offset:384
    buffer_load_dwordx4 v[92:95], v16, s[12:15], 0 offen offset:448
    buffer_load_dwordx4 v[96:99], v16, s[12:15], 0 offen offset:512
    buffer_load_dwordx4 v[100:103], v16, s[12:15], 0 offen offset:576
    buffer_load_dwordx4 v[104:107], v16, s[12:15], 0 offen offset:640
    buffer_load_dwordx4 v[108:111], v16, s[12:15], 0 offen offset:704
    buffer_load_dwordx4 v[112:115], v16, s[12:15], 0 offen offset:768
    buffer_load_dwordx4 v[116:119], v16, s[12:15], 0 offen offset:832
    buffer_load_dwordx4 v[120:123], v16, s[12:15], 0 offen offset:896
    buffer_load_dwordx4 v[124:127], v16, s[12:15], 0 offen offset:960
    v_add_u32 v13, 16384, v15
    v_xor_b32 v14, 64, v13
    v_mov_b64 v[128:129], 0
    v_mov_b64 v[130:131], 0
    v_mov_b64 v[132:133], 0
    v_mov_b64 v[134:135], 0
    v_mov_b64 v[136:137], 0
    v_mov_b64 v[138:139], 0
    v_mov_b64 v[140:141], 0
    v_mov_b64 v[142:143], 0
    ds_read_b128 v[32:35], v13 offset:0
    ds_read_b128 v[36:39], v13 offset:2048
    ds_read_b128 v[40:43], v13 offset:4096
    ds_read_b128 v[44:47], v13 offset:6144
    ds_read_b128 v[48:51], v14 offset:0
    ds_read_b128 v[52:55], v14 offset:2048
    ds_read_b128 v[56:59], v14 offset:4096
    ds_read_b128 v[60:63], v14 offset:6144
    s_waitcnt vmcnt(0)
    v_readfirstlane_b32 s27, v28
    s_mov_b32 s34, 0
NG_18:
    s_cmp_lg_u32 s27, 0
    s_cbranch_scc1 NG_18_x
    s_add_u32 s34, s34, 1
    s_cmp_ge_u32 s34, 16384
    s_cbranch_scc1 NG_18_x
    buffer_load_dword v28, v2, s[60:63], 0 offen sc1
    s_waitcnt vmcnt(0)
    v_readfirstlane_b32 s27, v28
    s_branch NG_18
NG_18_x:
    s_waitcnt lgkmcnt(0)
    ds_read_b128 v[160:163], v13 offset:8192
    ds_read_b128 v[164:167], v13 offset:10240
    ds_read_b128 v[168:171], v13 offset:12288
    ds_read_b128 v[172:175], v13 offset:14336
    ds_read_b128 v[176:179], v14 offset:8192
    ds_read_b128 v[180:183], v14 offset:10240
    ds_read_b128 v[184:187], v14 offset:12288
    ds_read_b128 v[188:191], v14 offset:14336
    v_mfma_f32_16x16x32_bf16 v[128:131], v[64:67], v[32:35], v[128:131]
    v_mfma_f32_16x16x32_bf16 v[128:131], v[68:71], v[48:51], v[128:131]
    v_mfma_f32_16x16x32_bf16 v[132:135], v[64:67], v[36:39], v[132:135]
    v_mfma_f32_16x16x32_bf16 v[132:135], v[68:71], v[52:55], v[132:135]
    v_mfma_f32_16x16x32_bf16 v[136:139], v[64:67], v[40:43], v[136:139]
    v_mfma_f32_16x16x32_bf16 v[136:139], v[68:71], v[56:59], v[136:139]
    v_mfma_f32_16x16x32_bf16 v[140:143], v[64:67], v[44:47], v[140:143]
    v_mfma_f32_16x16x32_bf16 v[140:143], v[68:71], v[60:63], v[140:143]
    s_waitcnt lgkmcnt(0)
    ds_read_b128 v[32:35], v13 offset:16384
    ds_read_b128 v[36:39], v13 offset:18432
    ds_read_b128 v[40:43], v13 offset:20480
    ds_read_b128 v[44:47], v13 offset:22528
    ds_read_b128 v[48:51], v14 offset:16384
    ds_read_b128 v[52:55], v14 offset:18432
    ds_read_b128 v[56:59], v14 offset:20480
    ds_read_b128 v[60:63], v14 offset:22528
    v_mfma_f32_16x16x32_bf16 v[128:131], v[72:75], v[160:163], v[128:131]
    v_mfma_f32_16x16x32_bf16 v[128:131], v[76:79], v[176:179], v[128:131]
    v_mfma_f32_16x16x32_bf16 v[132:135], v[72:75], v[164:167], v[132:135]
    v_mfma_f32_16x16x32_bf16 v[132:135], v[76:79], v[180:183], v[132:135]
    v_mfma_f32_16x16x32_bf16 v[136:139], v[72:75], v[168:171], v[136:139]
    v_mfma_f32_16x16x32_bf16 v[136:139], v[76:79], v[184:187], v[136:139]
    v_mfma_f32_16x16x32_bf16 v[140:143], v[72:75], v[172:175], v[140:143]
    v_mfma_f32_16x16x32_bf16 v[140:143], v[76:79], v[188:191], v[140:143]
    s_waitcnt lgkmcnt(0)
    ds_read_b128 v[160:163], v13 offset:24576
    ds_read_b128 v[164:167], v13 offset:26624
    ds_read_b128 v[168:171], v13 offset:28672
    ds_read_b128 v[172:175], v13 offset:30720
    ds_read_b128 v[176:179], v14 offset:24576
    ds_read_b128 v[180:183], v14 offset:26624
    ds_read_b128 v[184:187], v14 offset:28672
    ds_read_b128 v[188:191], v14 offset:30720
    v_mfma_f32_16x16x32_bf16 v[128:131], v[80:83], v[32:35], v[128:131]
    v_mfma_f32_16x16x32_bf16 v[128:131], v[84:87], v[48:51], v[128:131]
    v_mfma_f32_16x16x32_bf16 v[132:135], v[80:83], v[36:39], v[132:135]
    v_mfma_f32_16x16x32_bf16 v[132:135], v[84:87], v[52:55], v[132:135]
    v_mfma_f32_16x16x32_bf16 v[136:139], v[80:83], v[40:43], v[136:139]
    v_mfma_f32_16x16x32_bf16 v[136:139], v[84:87], v[56:59], v[136:139]
    v_mfma_f32_16x16x32_bf16 v[140:143], v[80:83], v[44:47], v[140:143]
    v_mfma_f32_16x16x32_bf16 v[140:143], v[84:87], v[60:63], v[140:143]
    s_waitcnt lgkmcnt(0)
    ds_read_b128 v[32:35], v13 offset:32768
    ds_read_b128 v[36:39], v13 offset:34816
    ds_read_b128 v[40:43], v13 offset:36864
    ds_read_b128 v[44:47], v13 offset:38912
    ds_read_b128 v[48:51], v14 offset:32768
    ds_read_b128 v[52:55], v14 offset:34816
    ds_read_b128 v[56:59], v14 offset:36864
    ds_read_b128 v[60:63], v14 offset:38912
    v_mfma_f32_16x16x32_bf16 v[128:131], v[88:91], v[160:163], v[128:131]
    v_mfma_f32_16x16x32_bf16 v[128:131], v[92:95], v[176:179], v[128:131]
    v_mfma_f32_16x16x32_bf16 v[132:135], v[88:91], v[164:167], v[132:135]
    v_mfma_f32_16x16x32_bf16 v[132:135], v[92:95], v[180:183], v[132:135]
    v_mfma_f32_16x16x32_bf16 v[136:139], v[88:91], v[168:171], v[136:139]
    v_mfma_f32_16x16x32_bf16 v[136:139], v[92:95], v[184:187], v[136:139]
    v_mfma_f32_16x16x32_bf16 v[140:143], v[88:91], v[172:175], v[140:143]
    v_mfma_f32_16x16x32_bf16 v[140:143], v[92:95], v[188:191], v[140:143]
    s_waitcnt lgkmcnt(0)
    ds_read_b128 v[160:163], v13 offset:40960
    ds_read_b128 v[164:167], v13 offset:43008
    ds_read_b128 v[168:171], v13 offset:45056
    ds_read_b128 v[172:175], v13 offset:47104
    ds_read_b128 v[176:179], v14 offset:40960
    ds_read_b128 v[180:183], v14 offset:43008
    ds_read_b128 v[184:187], v14 offset:45056
    ds_read_b128 v[188:191], v14 offset:47104
    v_mfma_f32_16x16x32_bf16 v[128:131], v[96:99], v[32:35], v[128:131]
    v_mfma_f32_16x16x32_bf16 v[128:131], v[100:103], v[48:51], v[128:131]
    v_mfma_f32_16x16x32_bf16 v[132:135], v[96:99], v[36:39], v[132:135]
    v_mfma_f32_16x16x32_bf16 v[132:135], v[100:103], v[52:55], v[132:135]
    v_mfma_f32_16x16x32_bf16 v[136:139], v[96:99], v[40:43], v[136:139]
    v_mfma_f32_16x16x32_bf16 v[136:139], v[100:103], v[56:59], v[136:139]
    v_mfma_f32_16x16x32_bf16 v[140:143], v[96:99], v[44:47], v[140:143]
    v_mfma_f32_16x16x32_bf16 v[140:143], v[100:103], v[60:63], v[140:143]
    s_waitcnt lgkmcnt(0)
    ds_read_b128 v[32:35], v13 offset:49152
    ds_read_b128 v[36:39], v13 offset:51200
    ds_read_b128 v[40:43], v13 offset:53248
    ds_read_b128 v[44:47], v13 offset:55296
    ds_read_b128 v[48:51], v14 offset:49152
    ds_read_b128 v[52:55], v14 offset:51200
    ds_read_b128 v[56:59], v14 offset:53248
    ds_read_b128 v[60:63], v14 offset:55296
    v_mfma_f32_16x16x32_bf16 v[128:131], v[104:107], v[160:163], v[128:131]
    v_mfma_f32_16x16x32_bf16 v[128:131], v[108:111], v[176:179], v[128:131]
    v_mfma_f32_16x16x32_bf16 v[132:135], v[104:107], v[164:167], v[132:135]
    v_mfma_f32_16x16x32_bf16 v[132:135], v[108:111], v[180:183], v[132:135]
    v_mfma_f32_16x16x32_bf16 v[136:139], v[104:107], v[168:171], v[136:139]
    v_mfma_f32_16x16x32_bf16 v[136:139], v[108:111], v[184:187], v[136:139]
    v_mfma_f32_16x16x32_bf16 v[140:143], v[104:107], v[172:175], v[140:143]
    v_mfma_f32_16x16x32_bf16 v[140:143], v[108:111], v[188:191], v[140:143]
    s_waitcnt lgkmcnt(0)
    ds_read_b128 v[160:163], v13 offset:57344
    ds_read_b128 v[164:167], v13 offset:59392
    ds_read_b128 v[168:171], v13 offset:61440
    ds_read_b128 v[172:175], v13 offset:63488
    ds_read_b128 v[176:179], v14 offset:57344
    ds_read_b128 v[180:183], v14 offset:59392
    ds_read_b128 v[184:187], v14 offset:61440
    ds_read_b128 v[188:191], v14 offset:63488
    v_mfma_f32_16x16x32_bf16 v[128:131], v[112:115], v[32:35], v[128:131]
    v_mfma_f32_16x16x32_bf16 v[128:131], v[116:119], v[48:51], v[128:131]
    v_mfma_f32_16x16x32_bf16 v[132:135], v[112:115], v[36:39], v[132:135]
    v_mfma_f32_16x16x32_bf16 v[132:135], v[116:119], v[52:55], v[132:135]
    v_mfma_f32_16x16x32_bf16 v[136:139], v[112:115], v[40:43], v[136:139]
    v_mfma_f32_16x16x32_bf16 v[136:139], v[116:119], v[56:59], v[136:139]
    v_mfma_f32_16x16x32_bf16 v[140:143], v[112:115], v[44:47], v[140:143]
    v_mfma_f32_16x16x32_bf16 v[140:143], v[116:119], v[60:63], v[140:143]
    s_waitcnt lgkmcnt(0)
    v_mfma_f32_16x16x32_bf16 v[128:131], v[120:123], v[160:163], v[128:131]
    v_mfma_f32_16x16x32_bf16 v[128:131], v[124:127], v[176:179], v[128:131]
    v_mfma_f32_16x16x32_bf16 v[132:135], v[120:123], v[164:167], v[132:135]
    v_mfma_f32_16x16x32_bf16 v[132:135], v[124:127], v[180:183], v[132:135]
    v_mfma_f32_16x16x32_bf16 v[136:139], v[120:123], v[168:171], v[136:139]
    v_mfma_f32_16x16x32_bf16 v[136:139], v[124:127], v[184:187], v[136:139]
    v_mfma_f32_16x16x32_bf16 v[140:143], v[120:123], v[172:175], v[140:143]
    v_mfma_f32_16x16x32_bf16 v[140:143], v[124:127], v[188:191], v[140:143]
    s_nop 7
    v_mul_f32 v16, 0xbfb8aa3b, v128
    v_mul_f32 v17, 0xbfb8aa3b, v132
    v_mul_f32 v18, 0xbfb8aa3b, v136
    v_mul_f32 v19, 0xbfb8aa3b, v140
    v_exp_f32 v16, v16
    v_exp_f32 v17, v17
    v_exp_f32 v18, v18
    v_exp_f32 v19, v19
    v_add_f32 v16, 1.0, v16
    v_add_f32 v17, 1.0, v17
    v_add_f32 v18, 1.0, v18
    v_add_f32 v19, 1.0, v19
    v_rcp_f32 v16, v16
    v_rcp_f32 v17, v17
    v_rcp_f32 v18, v18
    v_rcp_f32 v19, v19
    v_lshlrev_b32 v20, 2, v1
    s_lshl_b32 s29, s25, 8
    s_add_u32 s29, s29, 0x1600000
    s_mov_b32 exec_lo, 0xffff
    s_mov_b32 exec_hi, 0
    buffer_store_dword v16, v20, s[16:19], s29 offen offset:0 sc1
    buffer_store_dword v17, v20, s[16:19], s29 offen offset:64 sc1
    buffer_store_dword v18, v20, s[16:19], s29 offen offset:128 sc1
    buffer_store_dword v19, v20, s[16:19], s29 offen offset:192 sc1
    s_mov_b64 exec, -1
    s_lshl_b32 s28, s25, 7
    s_add_u32 s28, s28, 0x1691000
    s_waitcnt vmcnt(0)
    v_mov_b32 v16, s27
    s_mov_b64 exec, 1
    buffer_store_dword v16, v2, s[16:19], s28 offen sc1
    s_mov_b64 exec, -1
    s_branch L_G7X
L_G7N:
    s_waitcnt vmcnt(0)
    v_readfirstlane_b32 s27, v28
    s_mov_b32 s34, 0
NG_19:
    s_cmp_lg_u32 s27, 0
    s_cbranch_scc1 NG_19_x
    s_add_u32 s34, s34, 1
    s_cmp_ge_u32 s34, 16384
    s_cbranch_scc1 NG_19_x
    buffer_load_dword v28, v2, s[60:63], 0 offen sc1
    s_waitcnt vmcnt(0)
    v_readfirstlane_b32 s27, v28
    s_branch NG_19
NG_19_x:
L_G7X:
    s_mov_b64 exec, 1
    ds_add_u32 v2, v3 offset:0
    s_mov_b64 exec, -1
    s_mov_b32 s12, s46
    s_mov_b32 s13, s47
    s_mov_b32 s14, 0x800000
    s_mov_b32 s15, 0x20000
    v_lshrrev_b32 v19, 1, v1
    v_lshlrev_b32 v19, 12, v19
    v_and_b32 v18, 1, v1
    v_lshl_add_u32 v19, v18, 7, v19
    s_lshl_b32 s32, s25, 18
    s_lshl_b32 s33, s7, 10
    s_add_u32 s33, s33, s32
    s_mov_b32 s34, 0
LW_20:
    s_sleep 16
    ds_read_b32 v16, v2 offset:32
    s_waitcnt lgkmcnt(0)
    v_readfirstlane_b32 s35, v16
    s_add_u32 s34, s34, 1
    s_cmp_ge_u32 s34, 131072
    s_cbranch_scc1 LW_20_x
    s_cmp_lt_u32 s35, 16843009
    s_cbranch_scc1 LW_20
LW_20_x:
    s_add_u32 s32, s33, 0
    buffer_load_dword v20, v19, s[12:15], s32 offen
    s_waitcnt vmcnt(0)
    s_add_u32 s32, s33, 131072
    buffer_load_dword v20, v19, s[12:15], s32 offen
    s_waitcnt vmcnt(0)
    s_add_u32 s32, s33, 256
    buffer_load_dword v20, v19, s[12:15], s32 offen
    s_waitcnt vmcnt(0)
    s_add_u32 s32, s33, 131328
    buffer_load_dword v20, v19, s[12:15], s32 offen
    s_waitcnt vmcnt(0)
    s_lshl_b32 s20, s25, 2
    s_add_u32 s20, s20, s7
    s_and_b32 s21, s20, 7
    s_lshr_b32 s20, s20, 3
    s_mov_b32 s22, s20
    s_mov_b32 s28, 1024
    s_lshl_b32 s29, s21, 7
    v_lshrrev_b32 v16, 3, v1
    v_mul_lo_u32 v16, v16, s28
    v_bfe_u32 v17, v1, 4, 1
    v_lshlrev_b32 v17, 1, v17
    v_and_b32 v18, 7, v1
    v_xor_b32 v17, v17, v18
    v_lshl_add_u32 v16, v17, 4, v16
    v_add_u32 v5, s29, v16
    s_lshl_b32 s32, s28, 3
    s_sub_u32 s32, s32, 1024
    v_xor_b32 v6, 64, v5
    v_add_u32 v6, s32, v6
    s_lshl_b32 s32, s32, 1
    v_add_u32 v7, s32, v5
    v_add_u32 v8, s32, v6
L_WT:
    s_mov_b32 s8, s50
    s_mov_b32 s9, s51
    s_mov_b32 s10, 0xe0000
    s_mov_b32 s11, 0x20000
    s_lshl_b32 s31, s22, 15
    s_cmp_lt_u32 s22, 28
    s_cbranch_scc1 L_WT2
    s_mov_b32 s8, s40
    s_mov_b32 s9, s41
    s_mov_b32 s10, 0x80000
    s_mov_b32 s11, 0x20000
    s_sub_u32 s31, s31, 917504
L_WT2:
    s_add_u32 m0, s30, 0
    s_nop 0
    buffer_load_dwordx4 v5, s[8:11], s31 offen offset:0 lds
    buffer_load_dwordx4 v6, s[8:11], s31 offen offset:1024 lds
    buffer_load_dwordx4 v7, s[8:11], s31 offen offset:2048 lds
    buffer_load_dwordx4 v8, s[8:11], s31 offen offset:3072 lds
    s_add_u32 s31, s31, s29
    s_mul_i32 s31, s21, 44
    s_add_u32 s31, s31, s22
    s_lshl_b32 s31, s31, 12
    s_add_u32 s31, s31, 0x1400000
    s_waitcnt vmcnt(0)
    ds_read_b64_tr_b16 v[32:33], v9 offset:32768
    ds_read_b64_tr_b16 v[34:35], v9 offset:33280
    ds_read_b64_tr_b16 v[36:37], v10 offset:32768
    ds_read_b64_tr_b16 v[38:39], v10 offset:33280
    ds_read_b64_tr_b16 v[40:41], v11 offset:32768
    ds_read_b64_tr_b16 v[42:43], v11 offset:33280
    ds_read_b64_tr_b16 v[44:45], v12 offset:32768
    ds_read_b64_tr_b16 v[46:47], v12 offset:33280
    s_waitcnt lgkmcnt(0)
    buffer_store_dwordx4 v[32:35], v4, s[16:19], s31 offen offset:0 sc1
    buffer_store_dwordx4 v[36:39], v4, s[16:19], s31 offen offset:1024 sc1
    buffer_store_dwordx4 v[40:43], v4, s[16:19], s31 offen offset:2048 sc1
    buffer_store_dwordx4 v[44:47], v4, s[16:19], s31 offen offset:3072 sc1
    s_add_u32 s22, s22, 16
    s_cmp_lt_u32 s22, 44
    s_cbranch_scc1 L_WT
    s_lshl_b32 s31, s21, 11
    s_lshl_b32 s32, s20, 7
    s_add_u32 s31, s31, s32
    s_add_u32 s31, s31, 0x16bc000
    s_waitcnt vmcnt(0)
    v_mov_b32 v16, s27
    s_mov_b64 exec, 1
    buffer_store_dword v16, v2, s[16:19], s31 offen sc1
    s_mov_b64 exec, -1
    s_add_u32 s32, s33, 512
    buffer_load_dword v20, v19, s[12:15], s32 offen
    s_waitcnt vmcnt(0)
    s_add_u32 s32, s33, 131584
    buffer_load_dword v20, v19, s[12:15], s32 offen
    s_waitcnt vmcnt(0)
    s_add_u32 s32, s33, 768
    buffer_load_dword v20, v19, s[12:15], s32 offen
    s_waitcnt vmcnt(0)
    s_add_u32 s32, s33, 131840
    buffer_load_dword v20, v19, s[12:15], s32 offen
    s_waitcnt vmcnt(0)
    v_and_b32 v24, 15, v1
    v_lshlrev_b32 v24, 7, v24
    s_lshl_b32 s28, s26, 11
    s_add_u32 s28, s28, 0x16bc000
    s_mov_b32 s34, 0
PL_21:
    buffer_load_dword v25, v24, s[16:19], s28 offen sc1
    s_waitcnt vmcnt(0)
    v_xor_b32 v25, s27, v25
    v_cmp_ne_u32 vcc, 0, v25
    s_add_u32 s34, s34, 1
    s_cmp_ge_u32 s34, 16384
    s_cbranch_scc1 PL_21_x
    s_cbranch_vccz PL_21_x
    s_sleep 32
    s_branch PL_21
PL_21_x:
    s_mul_i32 s29, s26, 44
    s_mul_i32 s32, s7, 7
    s_add_u32 s29, s29, s32
    s_lshl_b32 s29, s29, 12
    s_add_u32 s29, s29, 0x1400000
    buffer_load_dwordx4 v[96:99], v4, s[16:19], s29 offen offset:0 sc1
    buffer_load_dwordx4 v[100:103], v4, s[16:19], s29 offen offset:1024 sc1
    buffer_load_dwordx4 v[104:107], v4, s[16:19], s29 offen offset:2048 sc1
    buffer_load_dwordx4 v[108:111], v4, s[16:19], s29 offen offset:3072 sc1
    s_add_u32 s29, s29, 4096
    buffer_load_dwordx4 v[160:163], v4, s[16:19], s29 offen offset:0 sc1
    buffer_load_dwordx4 v[164:167], v4, s[16:19], s29 offen offset:1024 sc1
    buffer_load_dwordx4 v[168:171], v4, s[16:19], s29 offen offset:2048 sc1
    buffer_load_dwordx4 v[172:175], v4, s[16:19], s29 offen offset:3072 sc1
    s_add_u32 s29, s29, 4096
    buffer_load_dwordx4 v[176:179], v4, s[16:19], s29 offen offset:0 sc1
    buffer_load_dwordx4 v[180:183], v4, s[16:19], s29 offen offset:1024 sc1
    buffer_load_dwordx4 v[184:187], v4, s[16:19], s29 offen offset:2048 sc1
    buffer_load_dwordx4 v[188:191], v4, s[16:19], s29 offen offset:3072 sc1
    s_add_u32 s29, s29, 4096
    buffer_load_dwordx4 v[112:115], v4, s[16:19], s29 offen offset:0 sc1
    buffer_load_dwordx4 v[116:119], v4, s[16:19], s29 offen offset:1024 sc1
    buffer_load_dwordx4 v[120:123], v4, s[16:19], s29 offen offset:2048 sc1
    buffer_load_dwordx4 v[124:127], v4, s[16:19], s29 offen offset:3072 sc1
    s_add_u32 s29, s29, 4096
    buffer_load_dwordx4 v[192:195], v4, s[16:19], s29 offen offset:0 sc1
    buffer_load_dwordx4 v[196:199], v4, s[16:19], s29 offen offset:1024 sc1
    buffer_load_dwordx4 v[200:203], v4, s[16:19], s29 offen offset:2048 sc1
    buffer_load_dwordx4 v[204:207], v4, s[16:19], s29 offen offset:3072 sc1
    s_add_u32 s29, s29, 4096
    buffer_load_dwordx4 v[208:211], v4, s[16:19], s29 offen offset:0 sc1
    buffer_load_dwordx4 v[212:215], v4, s[16:19], s29 offen offset:1024 sc1
    buffer_load_dwordx4 v[216:219], v4, s[16:19], s29 offen offset:2048 sc1
    buffer_load_dwordx4 v[220:223], v4, s[16:19], s29 offen offset:3072 sc1
    s_add_u32 s29, s29, 4096
    buffer_load_dwordx4 v[224:227], v4, s[16:19], s29 offen offset:0 sc1
    buffer_load_dwordx4 v[228:231], v4, s[16:19], s29 offen offset:1024 sc1
    buffer_load_dwordx4 v[232:235], v4, s[16:19], s29 offen offset:2048 sc1
    buffer_load_dwordx4 v[236:239], v4, s[16:19], s29 offen offset:3072 sc1
    s_add_u32 s29, s29, 4096
    s_mov_b32 s34, 0
LW_22:
    s_sleep 16
    ds_read_b32 v16, v2 offset:56
    s_waitcnt lgkmcnt(0)
    v_readfirstlane_b32 s35, v16
    s_add_u32 s34, s34, 1
    s_cmp_ge_u32 s34, 131072
    s_cbranch_scc1 LW_22_x
    s_cmp_lt_u32 s35, 16843009
    s_cbranch_scc1 LW_22
LW_22_x:
    s_mul_i32 s29, s26, 44
    s_lshl_b32 s32, s7, 1
    s_add_u32 s32, s32, 36
    s_add_u32 s29, s29, s32
    s_lshl_b32 s29, s29, 12
    s_add_u32 s29, s29, 0x1400000
    s_lshl_b32 s33, s7, 14
    s_add_u32 s33, s33, 32768
    s_add_u32 m0, s33, 0
    s_nop 0
    buffer_load_dwordx4 v4, s[16:19], s29 offen offset:0 sc1 lds
    buffer_load_dwordx4 v4, s[16:19], s29 offen offset:1024 sc1 lds
    buffer_load_dwordx4 v4, s[16:19], s29 offen offset:2048 sc1 lds
    buffer_load_dwordx4 v4, s[16:19], s29 offen offset:3072 sc1 lds
    s_add_u32 s29, s29, 4096
    s_add_u32 m0, s33, 4096
    s_nop 0
    buffer_load_dwordx4 v4, s[16:19], s29 offen offset:0 sc1 lds
    buffer_load_dwordx4 v4, s[16:19], s29 offen offset:1024 sc1 lds
    buffer_load_dwordx4 v4, s[16:19], s29 offen offset:2048 sc1 lds
    buffer_load_dwordx4 v4, s[16:19], s29 offen offset:3072 sc1 lds
    s_sub_u32 s29, s29, 36864
    s_add_u32 m0, s33, 8192
    s_nop 0
    buffer_load_dwordx4 v4, s[16:19], s29 offen offset:0 sc1 lds
    buffer_load_dwordx4 v4, s[16:19], s29 offen offset:1024 sc1 lds
    buffer_load_dwordx4 v4, s[16:19], s29 offen offset:2048 sc1 lds
    buffer_load_dwordx4 v4, s[16:19], s29 offen offset:3072 sc1 lds
    s_add_u32 s29, s29, 4096
    s_add_u32 m0, s33, 12288
    s_nop 0
    buffer_load_dwordx4 v4, s[16:19], s29 offen offset:0 sc1 lds
    buffer_load_dwordx4 v4, s[16:19], s29 offen offset:1024 sc1 lds
    buffer_load_dwordx4 v4, s[16:19], s29 offen offset:2048 sc1 lds
    buffer_load_dwordx4 v4, s[16:19], s29 offen offset:3072 sc1 lds
    s_add_u32 s29, s29, 4096
    v_add_u32 v23, s33, v4
    s_mov_b32 s34, 0
LW_23:
    s_sleep 16
    ds_read_b32 v16, v2 offset:64
    s_waitcnt lgkmcnt(0)
    v_readfirstlane_b32 s35, v16
    s_add_u32 s34, s34, 1
    s_cmp_ge_u32 s34, 131072
    s_cbranch_scc1 LW_23_x
    s_cmp_lt_u32 s35, 16843009
    s_cbranch_scc1 LW_23
LW_23_x:
L_OUT:
    s_add_u32 s32, s7, 0
    s_and_b32 s32, s32, 3
    s_lshl_b32 s32, s32, 10
    v_add_u32 v16, s32, v4
    s_add_u32 s32, s7, 1
    s_and_b32 s32, s32, 3
    s_lshl_b32 s32, s32, 10
    v_add_u32 v17, s32, v4
    s_add_u32 s32, s7, 2
    s_and_b32 s32, s32, 3
    s_lshl_b32 s32, s32, 10
    v_add_u32 v18, s32, v4
    s_add_u32 s32, s7, 3
    s_and_b32 s32, s32, 3
    s_lshl_b32 s32, s32, 10
    v_add_u32 v19, s32, v4
    s_mul_i32 s33, s25, 44
    s_mul_i32 s32, s7, 7
    s_add_u32 s33, s33, s32
    s_lshl_b32 s33, s33, 12
    s_add_u32 s33, s33, 0xe00000
    v_min_u32 v20, 6, v1
    v_add_u32 v20, s32, v20
    v_lshlrev_b32 v20, 7, v20
    s_mov_b32 exec_lo, 0
    v_and_b32 v20, 3, v1
    v_bfe_u32 v21, v1, 2, 1
    v_lshl_add_u32 v20, v21, 4, v20
    s_lshl_b32 s32, s7, 2
    v_add_u32 v20, s32, v20
    v_lshlrev_b32 v20, 7, v20
    v_add_u32 v20, 0x20000, v20
    s_mov_b32 exec_lo, -1
    s_lshl_b32 s28, s25, 12
    s_add_u32 s28, s28, 0x16c0000
    s_mov_b32 s34, 0
PL_24:
    buffer_load_dword v21, v20, s[16:19], s28 offen sc1
    s_waitcnt vmcnt(0)
    v_xor_b32 v21, s27, v21
    v_cmp_ne_u32 vcc, 0, v21
    s_add_u32 s34, s34, 1
    s_cmp_ge_u32 s34, 16384
    s_cbranch_scc1 PL_24_x
    s_cbranch_vccz PL_24_x
    s_sleep 3
    s_branch PL_24
PL_24_x:
    buffer_load_dwordx4 v[24:27], v16, s[16:19], s33 offen sc1
    buffer_load_dwordx4 v[28:31], v17, s[16:19], s33 offen sc1
    buffer_load_dwordx4 v[32:35], v18, s[16:19], s33 offen sc1
    buffer_load_dwordx4 v[36:39], v19, s[16:19], s33 offen sc1
    s_add_u32 s33, s33, 4096
    buffer_load_dwordx4 v[40:43], v16, s[16:19], s33 offen sc1
    buffer_load_dwordx4 v[44:47], v17, s[16:19], s33 offen sc1
    buffer_load_dwordx4 v[48:51], v18, s[16:19], s33 offen sc1
    buffer_load_dwordx4 v[52:55], v19, s[16:19], s33 offen sc1
    s_add_u32 s33, s33, 4096
    buffer_load_dwordx4 v[56:59], v16, s[16:19], s33 offen sc1
    buffer_load_dwordx4 v[60:63], v17, s[16:19], s33 offen sc1
    buffer_load_dwordx4 v[240:243], v18, s[16:19], s33 offen sc1
    buffer_load_dwordx4 v[244:247], v19, s[16:19], s33 offen sc1
    s_add_u32 s33, s33, 4096
    buffer_load_dwordx4 v[248:251], v16, s[16:19], s33 offen sc1
    buffer_load_dwordx4 v[252:255], v17, s[16:19], s33 offen sc1
    s_setprio 0
    s_lshl_b32 s32, s7, 2
    v_mov_b32 v22, s32
    s_mul_i32 s22, s25, 44
    s_lshl_b32 s32, s7, 1
    s_add_u32 s22, s22, s32
    s_add_u32 s22, s22, 36
    s_lshl_b32 s22, s22, 12
    s_add_u32 s22, s22, 0xe00000
    s_sub_u32 s23, s22, 32768
    s_waitcnt vmcnt(13)
    v_mfma_f32_16x16x32_bf16 v[128:131], v[96:99], v[24:27], 0
    v_mfma_f32_16x16x32_bf16 v[132:135], v[100:103], v[24:27], 0
    v_mfma_f32_16x16x32_bf16 v[136:139], v[104:107], v[24:27], 0
    v_mfma_f32_16x16x32_bf16 v[140:143], v[108:111], v[24:27], 0
    buffer_load_dwordx4 v[24:27], v18, s[16:19], s33 offen sc1
    s_waitcnt vmcnt(13)
    v_mfma_f32_16x16x32_bf16 v[144:147], v[96:99], v[28:31], 0
    v_mfma_f32_16x16x32_bf16 v[148:151], v[100:103], v[28:31], 0
    v_mfma_f32_16x16x32_bf16 v[152:155], v[104:107], v[28:31], 0
    v_mfma_f32_16x16x32_bf16 v[156:159], v[108:111], v[28:31], 0
    buffer_load_dwordx4 v[28:31], v19, s[16:19], s33 offen sc1
    s_add_u32 s33, s33, 4096
    s_waitcnt vmcnt(13)
    v_mfma_f32_16x16x32_bf16 v[64:67], v[96:99], v[32:35], 0
    v_mfma_f32_16x16x32_bf16 v[68:71], v[100:103], v[32:35], 0
    v_mfma_f32_16x16x32_bf16 v[72:75], v[104:107], v[32:35], 0
    v_mfma_f32_16x16x32_bf16 v[76:79], v[108:111], v[32:35], 0
    buffer_load_dwordx4 v[32:35], v16, s[16:19], s33 offen sc1
    s_waitcnt vmcnt(13)
    v_mfma_f32_16x16x32_bf16 v[80:83], v[96:99], v[36:39], 0
    v_mfma_f32_16x16x32_bf16 v[84:87], v[100:103], v[36:39], 0
    v_mfma_f32_16x16x32_bf16 v[88:91], v[104:107], v[36:39], 0
    v_mfma_f32_16x16x32_bf16 v[92:95], v[108:111], v[36:39], 0
    buffer_load_dwordx4 v[36:39], v17, s[16:19], s33 offen sc1
    s_mov_b32 s34, 0
LW_25:
    s_sleep 2
    ds_read_b32 v21, v22 offset:96
    s_waitcnt lgkmcnt(0)
    v_readfirstlane_b32 s35, v21
    s_add_u32 s34, s34, 1
    s_cmp_ge_u32 s34, 131072
    s_cbranch_scc1 LW_25_x
    s_cmp_lt_u32 s35, 1
    s_cbranch_scc1 LW_25
LW_25_x:
    s_waitcnt vmcnt(13)
    v_mfma_f32_16x16x32_bf16 v[128:131], v[160:163], v[40:43], v[128:131]
    v_mfma_f32_16x16x32_bf16 v[132:135], v[164:167], v[40:43], v[132:135]
    v_mfma_f32_16x16x32_bf16 v[136:139], v[168:171], v[40:43], v[136:139]
    v_mfma_f32_16x16x32_bf16 v[140:143], v[172:175], v[40:43], v[140:143]
    buffer_load_dwordx4 v[40:43], v18, s[16:19], s33 offen sc1
    s_waitcnt vmcnt(13)
    v_mfma_f32_16x16x32_bf16 v[144:147], v[160:163], v[44:47], v[144:147]
    v_mfma_f32_16x16x32_bf16 v[148:151], v[164:167], v[44:47], v[148:151]
    v_mfma_f32_16x16x32_bf16 v[152:155], v[168:171], v[44:47], v[152:155]
    v_mfma_f32_16x16x32_bf16 v[156:159], v[172:175], v[44:47], v[156:159]
    buffer_load_dwordx4 v[44:47], v19, s[16:19], s33 offen sc1
    s_add_u32 s33, s33, 4096
    s_waitcnt vmcnt(13)
    v_mfma_f32_16x16x32_bf16 v[64:67], v[160:163], v[48:51], v[64:67]
    v_mfma_f32_16x16x32_bf16 v[68:71], v[164:167], v[48:51], v[68:71]
    v_mfma_f32_16x16x32_bf16 v[72:75], v[168:171], v[48:51], v[72:75]
    v_mfma_f32_16x16x32_bf16 v[76:79], v[172:175], v[48:51], v[76:79]
    buffer_load_dwordx4 v[48:51], v16, s[16:19], s33 offen sc1
    s_waitcnt vmcnt(13)
    v_mfma_f32_16x16x32_bf16 v[80:83], v[160:163], v[52:55], v[80:83]
    v_mfma_f32_16x16x32_bf16 v[84:87], v[164:167], v[52:55], v[84:87]
    v_mfma_f32_16x16x32_bf16 v[88:91], v[168:171], v[52:55], v[88:91]
    v_mfma_f32_16x16x32_bf16 v[92:95], v[172:175], v[52:55], v[92:95]
    buffer_load_dwordx4 v[52:55], v17, s[16:19], s33 offen sc1
    s_waitcnt vmcnt(13)
    v_mfma_f32_16x16x32_bf16 v[128:131], v[176:179], v[56:59], v[128:131]
    v_mfma_f32_16x16x32_bf16 v[132:135], v[180:183], v[56:59], v[132:135]
    v_mfma_f32_16x16x32_bf16 v[136:139], v[184:187], v[56:59], v[136:139]
    v_mfma_f32_16x16x32_bf16 v[140:143], v[188:191], v[56:59], v[140:143]
    buffer_load_dwordx4 v[56:59], v18, s[16:19], s33 offen sc1
    s_waitcnt vmcnt(13)
    v_mfma_f32_16x16x32_bf16 v[144:147], v[176:179], v[60:63], v[144:147]
    v_mfma_f32_16x16x32_bf16 v[148:151], v[180:183], v[60:63], v[148:151]
    v_mfma_f32_16x16x32_bf16 v[152:155], v[184:187], v[60:63], v[152:155]
    v_mfma_f32_16x16x32_bf16 v[156:159], v[188:191], v[60:63], v[156:159]
    buffer_load_dwordx4 v[60:63], v19, s[16:19], s33 offen sc1
    s_add_u32 s33, s33, 4096
    s_waitcnt vmcnt(13)
    v_mfma_f32_16x16x32_bf16 v[64:67], v[176:179], v[240:243], v[64:67]
    v_mfma_f32_16x16x32_bf16 v[68:71], v[180:183], v[240:243], v[68:71]
    v_mfma_f32_16x16x32_bf16 v[72:75], v[184:187], v[240:243], v[72:75]
    v_mfma_f32_16x16x32_bf16 v[76:79], v[188:191], v[240:243], v[76:79]
    buffer_load_dwordx4 v[240:243], v16, s[16:19], s33 offen sc1
    s_waitcnt vmcnt(13)
    v_mfma_f32_16x16x32_bf16 v[80:83], v[176:179], v[244:247], v[80:83]
    v_mfma_f32_16x16x32_bf16 v[84:87], v[180:183], v[244:247], v[84:87]
    v_mfma_f32_16x16x32_bf16 v[88:91], v[184:187], v[244:247], v[88:91]
    v_mfma_f32_16x16x32_bf16 v[92:95], v[188:191], v[244:247], v[92:95]
    buffer_load_dwordx4 v[244:247], v17, s[16:19], s33 offen sc1
    s_waitcnt vmcnt(13)
    v_mfma_f32_16x16x32_bf16 v[128:131], v[112:115], v[248:251], v[128:131]
    v_mfma_f32_16x16x32_bf16 v[132:135], v[116:119], v[248:251], v[132:135]
    v_mfma_f32_16x16x32_bf16 v[136:139], v[120:123], v[248:251], v[136:139]
    v_mfma_f32_16x16x32_bf16 v[140:143], v[124:127], v[248:251], v[140:143]
    buffer_load_dwordx4 v[248:251], v18, s[16:19], s33 offen sc1
    s_waitcnt vmcnt(13)
    v_mfma_f32_16x16x32_bf16 v[144:147], v[112:115], v[252:255], v[144:147]
    v_mfma_f32_16x16x32_bf16 v[148:151], v[116:119], v[252:255], v[148:151]
    v_mfma_f32_16x16x32_bf16 v[152:155], v[120:123], v[252:255], v[152:155]
    v_mfma_f32_16x16x32_bf16 v[156:159], v[124:127], v[252:255], v[156:159]
    buffer_load_dwordx4 v[252:255], v19, s[16:19], s33 offen sc1
    s_add_u32 s33, s33, 4096
    s_waitcnt vmcnt(13)
    v_mfma_f32_16x16x32_bf16 v[64:67], v[112:115], v[24:27], v[64:67]
    v_mfma_f32_16x16x32_bf16 v[68:71], v[116:119], v[24:27], v[68:71]
    v_mfma_f32_16x16x32_bf16 v[72:75], v[120:123], v[24:27], v[72:75]
    v_mfma_f32_16x16x32_bf16 v[76:79], v[124:127], v[24:27], v[76:79]
    s_waitcnt vmcnt(12)
    v_mfma_f32_16x16x32_bf16 v[80:83], v[112:115], v[28:31], v[80:83]
    v_mfma_f32_16x16x32_bf16 v[84:87], v[116:119], v[28:31], v[84:87]
    v_mfma_f32_16x16x32_bf16 v[88:91], v[120:123], v[28:31], v[88:91]
    v_mfma_f32_16x16x32_bf16 v[92:95], v[124:127], v[28:31], v[92:95]
    ds_read_b128 v[96:99], v23 offset:0
    ds_read_b128 v[100:103], v23 offset:1024
    ds_read_b128 v[104:107], v23 offset:2048
    ds_read_b128 v[108:111], v23 offset:3072
    s_waitcnt vmcnt(11)
    v_mfma_f32_16x16x32_bf16 v[128:131], v[192:195], v[32:35], v[128:131]
    v_mfma_f32_16x16x32_bf16 v[132:135], v[196:199], v[32:35], v[132:135]
    v_mfma_f32_16x16x32_bf16 v[136:139], v[200:203], v[32:35], v[136:139]
    v_mfma_f32_16x16x32_bf16 v[140:143], v[204:207], v[32:35], v[140:143]
    s_waitcnt vmcnt(10)
    v_mfma_f32_16x16x32_bf16 v[144:147], v[192:195], v[36:39], v[144:147]
    v_mfma_f32_16x16x32_bf16 v[148:151], v[196:199], v[36:39], v[148:151]
    v_mfma_f32_16x16x32_bf16 v[152:155], v[200:203], v[36:39], v[152:155]
    v_mfma_f32_16x16x32_bf16 v[156:159], v[204:207], v[36:39], v[156:159]
    ds_read_b128 v[160:163], v23 offset:4096
    ds_read_b128 v[164:167], v23 offset:5120
    ds_read_b128 v[168:171], v23 offset:6144
    ds_read_b128 v[172:175], v23 offset:7168
    s_waitcnt vmcnt(9)
    v_mfma_f32_16x16x32_bf16 v[64:67], v[192:195], v[40:43], v[64:67]
    v_mfma_f32_16x16x32_bf16 v[68:71], v[196:199], v[40:43], v[68:71]
    v_mfma_f32_16x16x32_bf16 v[72:75], v[200:203], v[40:43], v[72:75]
    v_mfma_f32_16x16x32_bf16 v[76:79], v[204:207], v[40:43], v[76:79]
    s_waitcnt vmcnt(8)
    v_mfma_f32_16x16x32_bf16 v[80:83], v[192:195], v[44:47], v[80:83]
    v_mfma_f32_16x16x32_bf16 v[84:87], v[196:199], v[44:47], v[84:87]
    v_mfma_f32_16x16x32_bf16 v[88:91], v[200:203], v[44:47], v[88:91]
    v_mfma_f32_16x16x32_bf16 v[92:95], v[204:207], v[44:47], v[92:95]
    ds_read_b128 v[176:179], v23 offset:8192
    ds_read_b128 v[180:183], v23 offset:9216
    ds_read_b128 v[184:187], v23 offset:10240
    ds_read_b128 v[188:191], v23 offset:11264
    s_waitcnt vmcnt(7)
    v_mfma_f32_16x16x32_bf16 v[128:131], v[208:211], v[48:51], v[128:131]
    v_mfma_f32_16x16x32_bf16 v[132:135], v[212:215], v[48:51], v[132:135]
    v_mfma_f32_16x16x32_bf16 v[136:139], v[216:219], v[48:51], v[136:139]
    v_mfma_f32_16x16x32_bf16 v[140:143], v[220:223], v[48:51], v[140:143]
    s_waitcnt vmcnt(6)
    v_mfma_f32_16x16x32_bf16 v[144:147], v[208:211], v[52:55], v[144:147]
    v_mfma_f32_16x16x32_bf16 v[148:151], v[212:215], v[52:55], v[148:151]
    v_mfma_f32_16x16x32_bf16 v[152:155], v[216:219], v[52:55], v[152:155]
    v_mfma_f32_16x16x32_bf16 v[156:159], v[220:223], v[52:55], v[156:159]
    s_waitcnt lgkmcnt(8)
    ds_read_b128 v[112:115], v23 offset:12288
    ds_read_b128 v[116:119], v23 offset:13312
    ds_read_b128 v[120:123], v23 offset:14336
    ds_read_b128 v[124:127], v23 offset:15360
    s_mov_b32 s33, s22
    buffer_load_dwordx4 v[24:27], v16, s[16:19], s33 offen sc1
    buffer_load_dwordx4 v[28:31], v17, s[16:19], s33 offen sc1
    buffer_load_dwordx4 v[32:35], v18, s[16:19], s33 offen sc1
    buffer_load_dwordx4 v[36:39], v19, s[16:19], s33 offen sc1
    s_add_u32 s33, s33, 4096
    buffer_load_dwordx4 v[40:43], v16, s[16:19], s33 offen sc1
    buffer_load_dwordx4 v[44:47], v17, s[16:19], s33 offen sc1
    buffer_load_dwordx4 v[48:51], v18, s[16:19], s33 offen sc1
    buffer_load_dwordx4 v[52:55], v19, s[16:19], s33 offen sc1
    s_add_u32 s33, s33, 4096
    s_waitcnt vmcnt(13)
    v_mfma_f32_16x16x32_bf16 v[64:67], v[208:211], v[56:59], v[64:67]
    v_mfma_f32_16x16x32_bf16 v[68:71], v[212:215], v[56:59], v[68:71]
    v_mfma_f32_16x16x32_bf16 v[72:75], v[216:219], v[56:59], v[72:75]
    v_mfma_f32_16x16x32_bf16 v[76:79], v[220:223], v[56:59], v[76:79]
    s_waitcnt vmcnt(12)
    v_mfma_f32_16x16x32_bf16 v[80:83], v[208:211], v[60:63], v[80:83]
    v_mfma_f32_16x16x32_bf16 v[84:87], v[212:215], v[60:63], v[84:87]
    v_mfma_f32_16x16x32_bf16 v[88:91], v[216:219], v[60:63], v[88:91]
    v_mfma_f32_16x16x32_bf16 v[92:95], v[220:223], v[60:63], v[92:95]
    s_mov_b32 s33, s23
    buffer_load_dwordx4 v[192:195], v16, s[16:19], s33 offen sc1
    buffer_load_dwordx4 v[196:199], v17, s[16:19], s33 offen sc1
    buffer_load_dwordx4 v[200:203], v18, s[16:19], s33 offen sc1
    buffer_load_dwordx4 v[204:207], v19, s[16:19], s33 offen sc1
    s_add_u32 s33, s33, 4096
    buffer_load_dwordx4 v[208:211], v16, s[16:19], s33 offen sc1
    buffer_load_dwordx4 v[212:215], v17, s[16:19], s33 offen sc1
    buffer_load_dwordx4 v[216:219], v18, s[16:19], s33 offen sc1
    buffer_load_dwordx4 v[220:223], v19, s[16:19], s33 offen sc1
    s_add_u32 s33, s33, 4096
    s_waitcnt vmcnt(19)
    v_mfma_f32_16x16x32_bf16 v[128:131], v[224:227], v[240:243], v[128:131]
    v_mfma_f32_16x16x32_bf16 v[132:135], v[228:231], v[240:243], v[132:135]
    v_mfma_f32_16x16x32_bf16 v[136:139], v[232:235], v[240:243], v[136:139]
    v_mfma_f32_16x16x32_bf16 v[140:143], v[236:239], v[240:243], v[140:143]
    s_waitcnt vmcnt(18)
    v_mfma_f32_16x16x32_bf16 v[144:147], v[224:227], v[244:247], v[144:147]
    v_mfma_f32_16x16x32_bf16 v[148:151], v[228:231], v[244:247], v[148:151]
    v_mfma_f32_16x16x32_bf16 v[152:155], v[232:235], v[244:247], v[152:155]
    v_mfma_f32_16x16x32_bf16 v[156:159], v[236:239], v[244:247], v[156:159]
    s_waitcnt vmcnt(17)
    v_mfma_f32_16x16x32_bf16 v[64:67], v[224:227], v[248:251], v[64:67]
    v_mfma_f32_16x16x32_bf16 v[68:71], v[228:231], v[248:251], v[68:71]
    v_mfma_f32_16x16x32_bf16 v[72:75], v[232:235], v[248:251], v[72:75]
    v_mfma_f32_16x16x32_bf16 v[76:79], v[236:239], v[248:251], v[76:79]
    s_waitcnt vmcnt(16)
    v_mfma_f32_16x16x32_bf16 v[80:83], v[224:227], v[252:255], v[80:83]
    v_mfma_f32_16x16x32_bf16 v[84:87], v[228:231], v[252:255], v[84:87]
    v_mfma_f32_16x16x32_bf16 v[88:91], v[232:235], v[252:255], v[88:91]
    v_mfma_f32_16x16x32_bf16 v[92:95], v[236:239], v[252:255], v[92:95]
    s_setprio 2
    s_waitcnt lgkmcnt(0)
    s_mov_b64 exec, 1
    ds_add_u32 v2, v3 offset:8
    s_mov_b64 exec, -1
    v_and_b32 v20, 6, v1
    v_lshlrev_b32 v20, 10, v20
    v_and_b32 v21, 1, v1
    v_lshl_add_u32 v20, v21, 9, v20
    s_mov_b32 s12, s54
    s_mov_b32 s13, s55
    s_mov_b32 s14, 0x200000
    s_mov_b32 s15, 0x20000
    s_add_u32 s32, s7, 1
    s_and_b32 s32, s32, 3
    s_mul_i32 s32, s32, 12288
    s_add_u32 s32, s32, 0
    v_add_u32 v9, s32, v4
    s_add_u32 s32, s7, 2
    s_and_b32 s32, s32, 3
    s_mul_i32 s32, s32, 12288
    s_add_u32 s32, s32, 4096
    v_add_u32 v10, s32, v4
    s_add_u32 s32, s7, 3
    s_and_b32 s32, s32, 3
    s_mul_i32 s32, s32, 12288
    s_add_u32 s32, s32, 8192
    v_add_u32 v11, s32, v4
    s_mul_i32 s32, s7, 12288
    v_add_u32 v8, s32, v4
    v_lshrrev_b32 v6, 3, v1
    v_and_b32 v7, 7, v1
    v_lshlrev_b32 v7, 4, v7
    v_lshl_add_u32 v5, v6, 10, v7
    v_mul_u32_u24 v13, 144, v6
    v_add3_u32 v13, v13, v7, s30
    v_and_b32 v6, 15, v1
    v_mul_u32_u24 v12, 144, v6
    v_lshrrev_b32 v6, 4, v1
    v_lshlrev_b32 v6, 3, v6
    v_add3_u32 v12, v12, v6, s30
    s_lshl_b32 s31, s25, 16
    s_lshl_b32 s32, s7, 14
    s_add_u32 s31, s31, s32
    s_lshl_b32 s32, s26, 7
    s_add_u32 s31, s31, s32
    s_mov_b32 s34, 0
L_OC0:
    s_waitcnt vmcnt(8)
    v_max3_u32 v21, v24, v25, v26
    v_max3_u32 v22, v27, v28, v29
    v_max3_u32 v21, v21, v30, v31
    v_max3_u32 v22, v22, v32, v33
    v_max3_u32 v21, v21, v34, v35
    v_max3_u32 v22, v22, v36, v37
    v_max3_u32 v21, v21, v38, v39
    v_max3_u32 v22, v22, v40, v41
    v_max3_u32 v21, v21, v42, v43
    v_max3_u32 v22, v22, v44, v45
    v_max3_u32 v21, v21, v46, v47
    v_max3_u32 v22, v22, v48, v49
    v_max3_u32 v21, v21, v50, v51
    v_max3_u32 v22, v22, v52, v53
    v_max3_u32 v21, v21, v54, v55
    v_max_u32 v21, v21, v22
    v_cmp_eq_u32 vcc, -1, v21
    s_add_u32 s34, s34, 1
    s_cmp_ge_u32 s34, 16384
    s_cbranch_scc1 L_OC0_x
    s_cbranch_vccz L_OC0_x
L_OC0_s:
    buffer_load_dword v21, v20, s[16:19], s22 offen sc1
    s_waitcnt vmcnt(0)
    v_cmp_eq_u32 vcc, -1, v21
    s_add_u32 s34, s34, 1
    s_cmp_ge_u32 s34, 16384
    s_cbranch_scc1 L_OC0_x
    s_cbranch_vccz L_OC0_r
    s_sleep 1
    s_branch L_OC0_s
L_OC0_r:
    s_mov_b32 s33, s22
    buffer_load_dwordx4 v[24:27], v16, s[16:19], s33 offen sc1
    buffer_load_dwordx4 v[28:31], v17, s[16:19], s33 offen sc1
    buffer_load_dwordx4 v[32:35], v18, s[16:19], s33 offen sc1
    buffer_load_dwordx4 v[36:39], v19, s[16:19], s33 offen sc1
    s_add_u32 s33, s33, 4096
    buffer_load_dwordx4 v[40:43], v16, s[16:19], s33 offen sc1
    buffer_load_dwordx4 v[44:47], v17, s[16:19], s33 offen sc1
    buffer_load_dwordx4 v[48:51], v18, s[16:19], s33 offen sc1
    buffer_load_dwordx4 v[52:55], v19, s[16:19], s33 offen sc1
    s_add_u32 s33, s33, 4096
    s_mov_b32 s33, s23
    buffer_load_dwordx4 v[192:195], v16, s[16:19], s33 offen sc1
    buffer_load_dwordx4 v[196:199], v17, s[16:19], s33 offen sc1
    buffer_load_dwordx4 v[200:203], v18, s[16:19], s33 offen sc1
    buffer_load_dwordx4 v[204:207], v19, s[16:19], s33 offen sc1
    s_add_u32 s33, s33, 4096
    buffer_load_dwordx4 v[208:211], v16, s[16:19], s33 offen sc1
    buffer_load_dwordx4 v[212:215], v17, s[16:19], s33 offen sc1
    buffer_load_dwordx4 v[216:219], v18, s[16:19], s33 offen sc1
    buffer_load_dwordx4 v[220:223], v19, s[16:19], s33 offen sc1
    s_add_u32 s33, s33, 4096
    s_branch L_OC0
L_OC0_x:
    v_mfma_f32_16x16x32_bf16 v[144:147], v[96:99], v[28:31], v[144:147]
    v_mfma_f32_16x16x32_bf16 v[144:147], v[160:163], v[44:47], v[144:147]
    v_mfma_f32_16x16x32_bf16 v[148:151], v[100:103], v[28:31], v[148:151]
    v_mfma_f32_16x16x32_bf16 v[148:151], v[164:167], v[44:47], v[148:151]
    v_mfma_f32_16x16x32_bf16 v[152:155], v[104:107], v[28:31], v[152:155]
    v_mfma_f32_16x16x32_bf16 v[152:155], v[168:171], v[44:47], v[152:155]
    v_mfma_f32_16x16x32_bf16 v[156:159], v[108:111], v[28:31], v[156:159]
    v_mfma_f32_16x16x32_bf16 v[156:159], v[172:175], v[44:47], v[156:159]
    v_mfma_f32_16x16x32_bf16 v[64:67], v[96:99], v[32:35], v[64:67]
    v_mfma_f32_16x16x32_bf16 v[64:67], v[160:163], v[48:51], v[64:67]
    v_mfma_f32_16x16x32_bf16 v[68:71], v[100:103], v[32:35], v[68:71]
    v_mfma_f32_16x16x32_bf16 v[68:71], v[164:167], v[48:51], v[68:71]
    v_mfma_f32_16x16x32_bf16 v[72:75], v[104:107], v[32:35], v[72:75]
    v_mfma_f32_16x16x32_bf16 v[72:75], v[168:171], v[48:51], v[72:75]
    v_mfma_f32_16x16x32_bf16 v[76:79], v[108:111], v[32:35], v[76:79]
    v_mfma_f32_16x16x32_bf16 v[76:79], v[172:175], v[48:51], v[76:79]
    v_mfma_f32_16x16x32_bf16 v[80:83], v[96:99], v[36:39], v[80:83]
    v_mfma_f32_16x16x32_bf16 v[80:83], v[160:163], v[52:55], v[80:83]
    v_mfma_f32_16x16x32_bf16 v[84:87], v[100:103], v[36:39], v[84:87]
    v_mfma_f32_16x16x32_bf16 v[84:87], v[164:167], v[52:55], v[84:87]
    v_mfma_f32_16x16x32_bf16 v[88:91], v[104:107], v[36:39], v[88:91]
    v_mfma_f32_16x16x32_bf16 v[88:91], v[168:171], v[52:55], v[88:91]
    v_mfma_f32_16x16x32_bf16 v[92:95], v[108:111], v[36:39], v[92:95]
    v_mfma_f32_16x16x32_bf16 v[92:95], v[172:175], v[52:55], v[92:95]
    v_mfma_f32_16x16x32_bf16 v[128:131], v[96:99], v[24:27], v[128:131]
    v_mfma_f32_16x16x32_bf16 v[128:131], v[160:163], v[40:43], v[128:131]
    v_mfma_f32_16x16x32_bf16 v[132:135], v[100:103], v[24:27], v[132:135]
    v_mfma_f32_16x16x32_bf16 v[132:135], v[164:167], v[40:43], v[132:135]
    v_mfma_f32_16x16x32_bf16 v[136:139], v[104:107], v[24:27], v[136:139]
    v_mfma_f32_16x16x32_bf16 v[136:139], v[168:171], v[40:43], v[136:139]
    v_mfma_f32_16x16x32_bf16 v[140:143], v[108:111], v[24:27], v[140:143]
    v_mfma_f32_16x16x32_bf16 v[140:143], v[172:175], v[40:43], v[140:143]
L_OC1:
    s_waitcnt vmcnt(0)
    v_max3_u32 v21, v192, v193, v194
    v_max3_u32 v22, v195, v196, v197
    v_max3_u32 v21, v21, v198, v199
    v_max3_u32 v22, v22, v200, v201
    v_max3_u32 v21, v21, v202, v203
    v_max3_u32 v22, v22, v204, v205
    v_max3_u32 v21, v21, v206, v207
    v_max3_u32 v22, v22, v208, v209
    v_max3_u32 v21, v21, v210, v211
    v_max3_u32 v22, v22, v212, v213
    v_max3_u32 v21, v21, v214, v215
    v_max3_u32 v22, v22, v216, v217
    v_max3_u32 v21, v21, v218, v219
    v_max3_u32 v22, v22, v220, v221
    v_max3_u32 v21, v21, v222, v223
    v_max_u32 v21, v21, v22
    v_cmp_eq_u32 vcc, -1, v21
    s_add_u32 s34, s34, 1
    s_cmp_ge_u32 s34, 16384
    s_cbranch_scc1 L_OC1_x
    s_cbranch_vccz L_OC1_x
L_OC1_s:
    buffer_load_dword v21, v20, s[16:19], s23 offen sc1
    s_waitcnt vmcnt(0)
    v_cmp_eq_u32 vcc, -1, v21
    s_add_u32 s34, s34, 1
    s_cmp_ge_u32 s34, 16384
    s_cbranch_scc1 L_OC1_x
    s_cbranch_vccz L_OC1_r
    s_sleep 1
    s_branch L_OC1_s
L_OC1_r:
    s_mov_b32 s33, s23
    buffer_load_dwordx4 v[192:195], v16, s[16:19], s33 offen sc1
    buffer_load_dwordx4 v[196:199], v17, s[16:19], s33 offen sc1
    buffer_load_dwordx4 v[200:203], v18, s[16:19], s33 offen sc1
    buffer_load_dwordx4 v[204:207], v19, s[16:19], s33 offen sc1
    s_add_u32 s33, s33, 4096
    buffer_load_dwordx4 v[208:211], v16, s[16:19], s33 offen sc1
    buffer_load_dwordx4 v[212:215], v17, s[16:19], s33 offen sc1
    buffer_load_dwordx4 v[216:219], v18, s[16:19], s33 offen sc1
    buffer_load_dwordx4 v[220:223], v19, s[16:19], s33 offen sc1
    s_add_u32 s33, s33, 4096
    s_branch L_OC1
L_OC1_x:
    s_barrier
    v_mfma_f32_16x16x32_bf16 v[144:147], v[176:179], v[196:199], v[144:147]
    v_mfma_f32_16x16x32_bf16 v[144:147], v[112:115], v[212:215], v[144:147]
    v_mfma_f32_16x16x32_bf16 v[148:151], v[180:183], v[196:199], v[148:151]
    v_mfma_f32_16x16x32_bf16 v[148:151], v[116:119], v[212:215], v[148:151]
    v_mfma_f32_16x16x32_bf16 v[152:155], v[184:187], v[196:199], v[152:155]
    v_mfma_f32_16x16x32_bf16 v[152:155], v[120:123], v[212:215], v[152:155]
    v_mfma_f32_16x16x32_bf16 v[156:159], v[188:191], v[196:199], v[156:159]
    v_mfma_f32_16x16x32_bf16 v[156:159], v[124:127], v[212:215], v[156:159]
    v_mfma_f32_16x16x32_bf16 v[64:67], v[176:179], v[200:203], v[64:67]
    v_mfma_f32_16x16x32_bf16 v[64:67], v[112:115], v[216:219], v[64:67]
    ds_write_b128 v9, v[144:147] offset:0
    v_mfma_f32_16x16x32_bf16 v[68:71], v[180:183], v[200:203], v[68:71]
    v_mfma_f32_16x16x32_bf16 v[68:71], v[116:119], v[216:219], v[68:71]
    ds_write_b128 v9, v[148:151] offset:1024
    v_mfma_f32_16x16x32_bf16 v[72:75], v[184:187], v[200:203], v[72:75]
    v_mfma_f32_16x16x32_bf16 v[72:75], v[120:123], v[216:219], v[72:75]
    ds_write_b128 v9, v[152:155] offset:2048
    v_mfma_f32_16x16x32_bf16 v[76:79], v[188:191], v[200:203], v[76:79]
    v_mfma_f32_16x16x32_bf16 v[76:79], v[124:127], v[216:219], v[76:79]
    ds_write_b128 v9, v[156:159] offset:3072
    v_mfma_f32_16x16x32_bf16 v[80:83], v[176:179], v[204:207], v[80:83]
    v_mfma_f32_16x16x32_bf16 v[80:83], v[112:115], v[220:223], v[80:83]
    ds_write_b128 v10, v[64:67] offset:0
    v_mfma_f32_16x16x32_bf16 v[84:87], v[180:183], v[204:207], v[84:87]
    v_mfma_f32_16x16x32_bf16 v[84:87], v[116:119], v[220:223], v[84:87]
    ds_write_b128 v10, v[68:71] offset:1024
    v_mfma_f32_16x16x32_bf16 v[88:91], v[184:187], v[204:207], v[88:91]
    v_mfma_f32_16x16x32_bf16 v[88:91], v[120:123], v[220:223], v[88:91]
    ds_write_b128 v10, v[72:75] offset:2048
    v_mfma_f32_16x16x32_bf16 v[92:95], v[188:191], v[204:207], v[92:95]
    v_mfma_f32_16x16x32_bf16 v[92:95], v[124:127], v[220:223], v[92:95]
    ds_write_b128 v10, v[76:79] offset:3072
    v_mfma_f32_16x16x32_bf16 v[128:131], v[176:179], v[192:195], v[128:131]
    v_mfma_f32_16x16x32_bf16 v[128:131], v[112:115], v[208:211], v[128:131]
    ds_write_b128 v11, v[80:83] offset:0
    v_mfma_f32_16x16x32_bf16 v[132:135], v[180:183], v[192:195], v[132:135]
    v_mfma_f32_16x16x32_bf16 v[132:135], v[116:119], v[208:211], v[132:135]
    ds_write_b128 v11, v[84:87] offset:1024
    v_mfma_f32_16x16x32_bf16 v[136:139], v[184:187], v[192:195], v[136:139]
    v_mfma_f32_16x16x32_bf16 v[136:139], v[120:123], v[208:211], v[136:139]
    ds_write_b128 v11, v[88:91] offset:2048
    v_mfma_f32_16x16x32_bf16 v[140:143], v[188:191], v[192:195], v[140:143]
    v_mfma_f32_16x16x32_bf16 v[140:143], v[124:127], v[208:211], v[140:143]
    ds_write_b128 v11, v[92:95] offset:3072
    s_waitcnt lgkmcnt(0)
    s_barrier
    ds_read_b128 v[192:195], v8 offset:0
    ds_read_b128 v[196:199], v8 offset:1024
    ds_read_b128 v[200:203], v8 offset:2048
    ds_read_b128 v[204:207], v8 offset:3072
    ds_read_b128 v[208:211], v8 offset:4096
    ds_read_b128 v[212:215], v8 offset:5120
    ds_read_b128 v[216:219], v8 offset:6144
    ds_read_b128 v[220:223], v8 offset:7168
    ds_read_b128 v[224:227], v8 offset:8192
    ds_read_b128 v[228:231], v8 offset:9216
    ds_read_b128 v[232:235], v8 offset:10240
    ds_read_b128 v[236:239], v8 offset:11264
    s_waitcnt lgkmcnt(8)
    v_pk_add_f32 v[128:129], v[128:129], v[192:193]
    v_pk_add_f32 v[130:131], v[130:131], v[194:195]
    v_pk_add_f32 v[132:133], v[132:133], v[196:197]
    v_pk_add_f32 v[134:135], v[134:135], v[198:199]
    v_pk_add_f32 v[136:137], v[136:137], v[200:201]
    v_pk_add_f32 v[138:139], v[138:139], v[202:203]
    v_pk_add_f32 v[140:141], v[140:141], v[204:205]
    v_pk_add_f32 v[142:143], v[142:143], v[206:207]
    s_waitcnt lgkmcnt(4)
    v_pk_add_f32 v[128:129], v[128:129], v[208:209]
    v_pk_add_f32 v[130:131], v[130:131], v[210:211]
    v_pk_add_f32 v[132:133], v[132:133], v[212:213]
    v_pk_add_f32 v[134:135], v[134:135], v[214:215]
    v_pk_add_f32 v[136:137], v[136:137], v[216:217]
    v_pk_add_f32 v[138:139], v[138:139], v[218:219]
    v_pk_add_f32 v[140:141], v[140:141], v[220:221]
    v_pk_add_f32 v[142:143], v[142:143], v[222:223]
    s_waitcnt lgkmcnt(0)
    v_pk_add_f32 v[128:129], v[128:129], v[224:225]
    v_pk_add_f32 v[130:131], v[130:131], v[226:227]
    v_pk_add_f32 v[132:133], v[132:133], v[228:229]
    v_pk_add_f32 v[134:135], v[134:135], v[230:231]
    v_pk_add_f32 v[136:137], v[136:137], v[232:233]
    v_pk_add_f32 v[138:139], v[138:139], v[234:235]
    v_pk_add_f32 v[140:141], v[140:141], v[236:237]
    v_pk_add_f32 v[142:143], v[142:143], v[238:239]
    v_cvt_pk_bf16_f32 v24, v128, v129
    v_cvt_pk_bf16_f32 v25, v130, v131
    ds_write_b64 v12, v[24:25] offset:0
    v_cvt_pk_bf16_f32 v26, v132, v133
    v_cvt_pk_bf16_f32 v27, v134, v135
    ds_write_b64 v12, v[26:27] offset:32
    v_cvt_pk_bf16_f32 v28, v136, v137
    v_cvt_pk_bf16_f32 v29, v138, v139
    ds_write_b64 v12, v[28:29] offset:64
    v_cvt_pk_bf16_f32 v30, v140, v141
    v_cvt_pk_bf16_f32 v31, v142, v143
    ds_write_b64 v12, v[30:31] offset:96
    s_waitcnt lgkmcnt(0)
    ds_read_b128 v[32:35], v13
    ds_read_b128 v[36:39], v13 offset:1152
    s_add_u32 s32, s31, 8192
    s_waitcnt lgkmcnt(1)
    buffer_store_dwordx4 v[32:35], v5, s[12:15], s31 offen sc1
    s_waitcnt lgkmcnt(0)
    buffer_store_dwordx4 v[36:39], v5, s[12:15], s32 offen sc1
L_FIN:
L_END:
    s_endpgm
.section .rodata,"a"
.p2align 6
.amdhsa_kernel gated_mix__softmax_full_mha__mixer_gmlp__prompt_kernel
  .amdhsa_next_free_vgpr 256
  .amdhsa_next_free_sgpr 100
  .amdhsa_accum_offset 256
  .amdhsa_group_segment_fixed_size 0
  .amdhsa_kernarg_size 96
  .amdhsa_user_sgpr_count 2
  .amdhsa_user_sgpr_kernarg_segment_ptr 1
  .amdhsa_system_sgpr_workgroup_id_x 1
  .amdhsa_float_denorm_mode_32 3
.end_amdhsa_kernel
```
